```python
import torch

def _softmax(x, axis=-1):
    return torch.softmax(x, dim=axis)
def _gelu(x):
    return torch.nn.functional.gelu(x, approximate="tanh")
def _silu(x):
    return torch.nn.functional.silu(x)
def _sigmoid(x):
    return torch.sigmoid(x)
def _layernorm(x, axis=-1, eps=1e-5):
    m = x.mean(dim=axis, keepdim=True)
    v = x.var(dim=axis, keepdim=True, unbiased=False)
    return (x - m) / torch.sqrt(v + eps)
def _scatter_add(tgt, idx, src, axis=0):
    return tgt.clone().index_add_(axis, idx, src)
def _segment_sum(src, seg, n):
    out = torch.zeros((n,) + src.shape[1:], dtype=src.dtype)
    return out.index_add_(0, seg, src)
def _pad(x, pw):
    flat = tuple(v for pair in reversed(pw) for v in pair)
    return torch.nn.functional.pad(x, flat)

kernel_name = 'sequential_preLN__sliding_block_cached__dense_activation_silu__decode'

def setup_inputs():

    _w = (lambda a: (lambda t: t.to(torch.bfloat16) if t.is_floating_point() else t)(torch.as_tensor(a)))
    def _A_setup():
        B, Sq, D = 1, 1, 576
        Hq, Hkv, Sk, Dh = 32, 16, 8192, 128
        assert Hq % Hkv == 0, (Hq, Hkv)
        return {
            "x": _w((lambda *s: torch.randn(*s, dtype=torch.bfloat16) * 0.05)(B, Sq, D)),
            "k_cache": _w((lambda *s: torch.randn(*s, dtype=torch.bfloat16) * 3.2)(B, Hkv, Sk, Dh)),
            "v_cache": _w((lambda *s: torch.randn(*s, dtype=torch.bfloat16) * 0.8)(B, Hkv, Sk, Dh)),
            "wq": _w((lambda *s: torch.randn(*s, dtype=torch.bfloat16) * 3.2)(D, Hq * Dh) * (D ** -0.5)),
            "wo": _w((lambda *s: torch.randn(*s, dtype=torch.bfloat16) * 0.8)(Hq * Dh, D) * ((Hq * Dh) ** -0.5)),
        }
    _A_in = _A_setup()

    def _B_setup():
        B, S, D, F = 1, 1, 576, 4608
        return {
            "x": _w((lambda *s: torch.randn(*s, dtype=torch.bfloat16) * 0.05)(B, S, D)),
            "w1": _w((lambda *s: torch.randn(*s, dtype=torch.bfloat16) * 3.2)(D, F) * (D ** -0.5)),
            "w2": _w((lambda *s: torch.randn(*s, dtype=torch.bfloat16) * 0.4)(F, D) * (F ** -0.5)),
        }
    _B_in = _B_setup()

    return {
        "A_x": _A_in["x"],
        "A_k_cache": _A_in["k_cache"],
        "A_v_cache": _A_in["v_cache"],
        "A_wq": _A_in["wq"],
        "A_wo": _A_in["wo"],
        "B_x": _B_in["x"],
        "B_w1": _B_in["w1"],
        "B_w2": _B_in["w2"],
    }

def reference(A_x, A_k_cache, A_v_cache, A_wq, A_wo, B_x, B_w1, B_w2):
    def _A_ref(x, k_cache, v_cache, wq, wo):
        B, Sq, D = x.shape
        Hq, Dh = 32, 128
        Hkv, Sk = k_cache.shape[1], k_cache.shape[2]
        W = min(4096, max(256, Sk // 4))
        rep = Hq // Hkv
        q = (lambda x, *d: x.permute(*d))((x @ wq).reshape(B, Sq, Hq, Dh), 0, 2, 1, 3)
        k = (lambda x, n, axis: torch.repeat_interleave(x, n, dim=axis))(k_cache[:, :, Sk - W:, :], rep, axis=1)
        v = (lambda x, n, axis: torch.repeat_interleave(x, n, dim=axis))(v_cache[:, :, Sk - W:, :], rep, axis=1)
        scores = torch.einsum("bhqd,bhkd->bhqk", q, k) * (Dh ** -0.5)
        p = _softmax(scores, axis=-1)
        o = torch.einsum("bhqk,bhkd->bhqd", p, v)
        return (lambda x, *d: x.permute(*d))(o, 0, 2, 1, 3).reshape(B, Sq, Hq * Dh) @ wo

    def _B_ref(x, w1, w2):
        h = torch.einsum("bsd,df->bsf", x, w1)
        h = _silu(h)
        out = torch.einsum("bsf,fd->bsd", h, w2)
        return out

    x = A_x
    h = x + _A_ref(_layernorm(x, axis=-1), A_k_cache, A_v_cache, A_wq, A_wo)
    h2 = h + _B_ref(_layernorm(h, axis=-1), B_w1, B_w2)
    return h2
```

```asm
; @launch grid=(256,1,1) block=(768,1,1) lds=23552
.amdgcn_target "amdgcn-amd-amdhsa--gfx950"
.text
.globl sequential_preLN__sliding_block_cached__dense_activation_silu__decode_kernel
.p2align 8
.type sequential_preLN__sliding_block_cached__dense_activation_silu__decode_kernel,@function
sequential_preLN__sliding_block_cached__dense_activation_silu__decode_kernel:

    s_cmp_ge_u32 s2, 256
    s_cbranch_scc1 L_end
    s_load_dwordx16 s[16:31], s[0:1], 0
    s_load_dwordx4 s[32:35], s[0:1], 64
    s_load_dwordx2 s[36:37], s[0:1], 80
    v_lshrrev_b32 v1, 6, v0
    v_and_b32 v0, 63, v0
    v_readfirstlane_b32 s3, v1
    s_and_b32 s4, s2, 15
    s_lshr_b32 s5, s2, 4
    s_mov_b32 s7, 0xff
    v_lshrrev_b32 v1, 4, v0
    v_and_b32 v2, 15, v0
    v_and_b32 v3, 1, v0
    v_lshl_or_b32 v3, v1, 1, v3
    v_lshrrev_b32 v4, 1, v2
    v_and_b32 v6, 7, v0
    v_lshlrev_b32 v6, 4, v6
    v_lshrrev_b32 v7, 3, v0
    s_cmp_eq_u32 s3, 11
    s_cbranch_scc1 L_q
    v_lshlrev_b32 v16, 8, v4
    v_lshl_or_b32 v16, v3, 4, v16
    v_lshlrev_b32 v17, 9, v1
    v_lshl_or_b32 v17, v2, 4, v17
    s_lshl_b32 s8, s4, 21
    s_mul_i32 s9, s5, 11
    s_add_u32 s9, s9, s3
    s_mul_i32 s10, s3, 5
    s_add_u32 s10, s10, s5
    s_add_u32 s10, s10, 65
    s_cmp_lt_u32 s3, 9
    s_cselect_b32 s10, 128, s10
    s_cmp_lt_u32 s5, 11
    s_cselect_b32 s62, s9, s10
    s_min_u32 s9, s62, 127
    s_lshl_b32 s9, s9, 12
    s_add_u32 s8, s8, s9
    s_cmp_lt_u32 s3, 8
    s_cselect_b32 s63, s2, 255
    s_add_u32 s8, s8, 0x180000
    v_and_b32 v18, 3, v4
    v_lshlrev_b32 v18, 4, v18
    v_mov_b32 v10, 0xffff
    v_mov_b32 v11, 0
    v_lshlrev_b64 v[10:11], v18, v[10:11]
    v_cmp_gt_u32 vcc, 4, v4
    s_nop 1
    v_cndmask_b32 v8, 0, v10, vcc
    v_cndmask_b32 v9, 0, v11, vcc
    v_cndmask_b32 v10, v10, 0, vcc
    v_cndmask_b32 v11, v11, 0, vcc
    s_waitcnt lgkmcnt(0)
    s_load_dword s6, s[36:37], 0
    s_add_u32 s40, s18, s8
    s_addc_u32 s41, s19, 0
    s_add_u32 s44, s20, s8
    s_addc_u32 s45, s21, 0
    s_cmp_gt_u32 s3, 1
    s_cbranch_scc1 L_ncp
    s_getpc_b64 s[10:11]
L_pc:
    s_lshl_b32 s12, s3, 13
    v_lshlrev_b32 v18, 7, v0
    v_add_u32 v18, s12, v18
    v_min_u32 v18, L_end-L_pc, v18
    global_load_dword v127, v18, s[10:11]
L_ncp:
    s_barrier
    s_cmp_ge_u32 s62, 128
    s_cbranch_scc1 L_nt
    global_load_dwordx4 v[32:35], v16, s[40:41] offset:0 nt
    global_load_dwordx4 v[36:39], v16, s[40:41] offset:2048 nt
    v_and_b32 v19, 7, v2
    v_and_b32 v18, 3, v19
    v_lshlrev_b32 v18, 4, v18
    v_mov_b32 v14, 0xffff
    v_mov_b32 v15, 0
    v_lshlrev_b64 v[14:15], v18, v[14:15]
    v_cmp_gt_u32 vcc, 4, v19
    s_nop 1
    v_cndmask_b32 v12, 0, v14, vcc
    v_cndmask_b32 v13, 0, v15, vcc
    v_cndmask_b32 v14, v14, 0, vcc
    v_cndmask_b32 v15, v15, 0, vcc
    s_mov_b32 s12, 4608
    v_mul_lo_u32 v28, v7, s12
    v_lshl_add_u32 v29, v28, 3, v6
    v_add_u32 v28, v28, v6
    s_mul_i32 s12, s4, 294912
    s_mul_i32 s13, s3, 36864
    s_add_u32 s12, s12, s13
    s_min_u32 s38, s5, 8
    s_lshl_b32 s38, s38, 7
    s_add_u32 s14, s12, s38
    s_add_u32 s46, s24, s14
    s_addc_u32 s47, s25, 0
    s_mov_b32 s48, s28
    s_mov_b32 s49, s29
    s_mov_b32 s50, 5308416
    s_mov_b32 s51, 0x20000
    s_max_u32 s59, s2, 184
    s_sub_u32 s59, s59, 184
    s_mul_i32 s13, s3, 589824
    s_lshl_b32 s12, s59, 7
    s_add_u32 s56, s12, s13
    s_mul_i32 s12, s59, 73728
    s_lshl_b32 s13, s3, 7
    s_add_u32 s12, s12, s13
    s_add_u32 s52, s30, s12
    s_addc_u32 s53, s31, 0
    s_add_u32 s54, s52, 36864
    s_addc_u32 s55, s53, 0
    v_lshrrev_b32 v18, 3, v2
    v_lshlrev_b32 v18, 8, v18
    v_lshl_or_b32 v18, v1, 5, v18
    v_and_b32 v19, 1, v0
    v_lshl_or_b32 v18, v19, 4, v18
    s_cmp_ge_u32 s63, 144
    s_cbranch_scc1 L_xb1f
    s_waitcnt vmcnt(1)
    global_load_dwordx4 v[40:43], v16, s[40:41] offset:128 nt
    s_waitcnt vmcnt(1)
    global_load_dwordx4 v[44:47], v16, s[40:41] offset:2176 nt
    s_waitcnt vmcnt(2)
    global_load_dwordx4 v[48:51], v17, s[44:45] offset:0 nt
    s_waitcnt vmcnt(2)
    global_load_dwordx4 v[52:55], v17, s[44:45] offset:256 nt
    s_waitcnt vmcnt(2)
    global_load_dwordx4 v[56:59], v17, s[44:45] offset:2048 nt
    s_waitcnt vmcnt(2)
    global_load_dwordx4 v[60:63], v17, s[44:45] offset:2304 nt
    s_waitcnt lgkmcnt(0)
    s_add_u32 s6, s6, 1
    v_mov_b32 v5, s6
    s_barrier
    ds_read_b128 v[16:19], v18 offset:2560
    ds_read_b128 v[20:23], v18 offset:2688
    s_waitcnt vmcnt(4)
    global_load_dwordx4 v[64:67], v28, s[46:47] offset:0 nt
    global_load_dwordx4 v[68:71], v28, s[46:47] offset:1152 nt
    global_load_dwordx4 v[72:75], v28, s[46:47] offset:2304 nt
    global_load_dwordx4 v[76:79], v28, s[46:47] offset:3456 nt
    s_branch L_xb1d
L_xb1f:
    s_waitcnt vmcnt(1)
    global_load_dwordx4 v[40:43], v16, s[40:41] offset:128 nt
    s_waitcnt vmcnt(1)
    global_load_dwordx4 v[44:47], v16, s[40:41] offset:2176 nt
    s_waitcnt vmcnt(2)
    global_load_dwordx4 v[48:51], v17, s[44:45] offset:0 nt
    s_waitcnt vmcnt(2)
    global_load_dwordx4 v[52:55], v17, s[44:45] offset:256 nt
    s_waitcnt vmcnt(2)
    global_load_dwordx4 v[56:59], v17, s[44:45] offset:2048 nt
    s_waitcnt vmcnt(2)
    global_load_dwordx4 v[60:63], v17, s[44:45] offset:2304 nt
    s_waitcnt lgkmcnt(0)
    s_add_u32 s6, s6, 1
    v_mov_b32 v5, s6
    s_barrier
    ds_read_b128 v[16:19], v18 offset:2560
    ds_read_b128 v[20:23], v18 offset:2688
    s_waitcnt vmcnt(4)
L_xb1d:
    s_waitcnt lgkmcnt(0)
    v_mfma_f32_16x16x32_bf16 v[112:115], v[32:35], v[16:19], 0
    v_mfma_f32_16x16x32_bf16 v[116:119], v[36:39], v[16:19], 0
    v_mfma_f32_16x16x32_bf16 v[112:115], v[40:43], v[20:23], v[112:115]
    v_mfma_f32_16x16x32_bf16 v[116:119], v[44:47], v[20:23], v[116:119]

    s_nop 6
    v_mov_b32_dpp v120, v112 quad_perm:[0,0,2,2] row_mask:0xf bank_mask:0xf
    v_mov_b32_dpp v121, v114 quad_perm:[0,0,2,2] row_mask:0xf bank_mask:0xf
    v_mov_b32_dpp v122, v116 quad_perm:[0,0,2,2] row_mask:0xf bank_mask:0xf
    v_mov_b32_dpp v123, v118 quad_perm:[0,0,2,2] row_mask:0xf bank_mask:0xf
    v_add_f32_dpp v24, v113, v120 quad_perm:[1,1,3,3] row_mask:0xf bank_mask:0xf
    v_add_f32_dpp v25, v115, v121 quad_perm:[1,1,3,3] row_mask:0xf bank_mask:0xf
    v_add_f32_dpp v26, v117, v122 quad_perm:[1,1,3,3] row_mask:0xf bank_mask:0xf
    v_add_f32_dpp v27, v119, v123 quad_perm:[1,1,3,3] row_mask:0xf bank_mask:0xf
    s_mov_b32 s12, 0x3db504f3
    s_mov_b32 s13, 1069066811
    v_cvt_pk_bf16_f32 v120, v24, v25
    v_cvt_pk_bf16_f32 v121, v26, v27
    v_lshlrev_b32 v24, 16, v120
    v_and_b32 v25, 0xffff0000, v120
    v_lshlrev_b32 v26, 16, v121
    v_and_b32 v27, 0xffff0000, v121
    v_mul_f32 v24, s12, v24
    v_mul_f32 v25, s12, v25
    v_mul_f32 v26, s12, v26
    v_mul_f32 v27, s12, v27
    v_cvt_pk_bf16_f32 v120, v24, v25
    v_cvt_pk_bf16_f32 v121, v26, v27
    v_lshlrev_b32 v24, 16, v120
    v_and_b32 v25, 0xffff0000, v120
    v_lshlrev_b32 v26, 16, v121
    v_and_b32 v27, 0xffff0000, v121

    v_max_f32 v122, v24, v25
    v_max3_f32 v122, v26, v27, v122
    v_mov_b32 v123, v122
    s_nop 1
    v_permlane16_swap_b32 v122, v123
    v_max_f32 v122, v122, v123
    v_mov_b32 v123, v122
    s_nop 1
    v_permlane32_swap_b32 v122, v123
    v_max_f32 v122, v122, v123
    v_mul_f32 v122, s13, v122
    v_fma_f32 v24, v24, s13, -v122
    v_fma_f32 v25, v25, s13, -v122
    v_fma_f32 v26, v26, s13, -v122
    v_fma_f32 v27, v27, s13, -v122
    v_exp_f32 v24, v24
    v_exp_f32 v25, v25
    v_exp_f32 v26, v26
    v_exp_f32 v27, v27
    v_lshrrev_b32 v124, 3, v2
    v_lshlrev_b32 v124, 7, v124
    s_lshl_b32 s12, s3, 3
    v_add_u32 v124, s12, v124
    v_add_f32 v123, v24, v25
    v_add_f32 v125, v26, v27
    v_add_f32 v123, v123, v125
    v_mov_b32 v125, v123
    s_nop 1
    v_permlane16_swap_b32 v123, v125
    v_add_f32 v123, v123, v125
    v_mov_b32 v125, v123
    s_nop 1
    v_permlane32_swap_b32 v123, v125
    v_add_f32 v123, v123, v125
    s_mov_b64 exec, 0x101
    ds_write_b64 v124, v[122:123] offset:3072
    s_mov_b64 exec, -1
    v_cvt_pk_bf16_f32 v24, v24, v24
    v_cvt_pk_bf16_f32 v25, v25, v25
    v_cvt_pk_bf16_f32 v26, v26, v26
    v_cvt_pk_bf16_f32 v27, v27, v27
    v_and_b32 v32, v24, v12
    v_and_b32 v33, v24, v13
    v_and_b32 v34, v24, v14
    v_and_b32 v35, v24, v15
    v_and_b32 v36, v25, v12
    v_and_b32 v37, v25, v13
    v_and_b32 v38, v25, v14
    v_and_b32 v39, v25, v15
    v_and_b32 v40, v26, v12
    v_and_b32 v41, v26, v13
    v_and_b32 v42, v26, v14
    v_and_b32 v43, v26, v15
    v_and_b32 v44, v27, v12
    v_and_b32 v45, v27, v13
    v_and_b32 v46, v27, v14
    v_and_b32 v47, v27, v15
    s_lshl_b32 s12, s3, 10
    v_lshlrev_b32 v124, 4, v0
    v_add_u32 v124, s12, v124
    s_waitcnt lgkmcnt(0)
    s_barrier
    s_cmp_ge_u32 s63, 144
    s_cbranch_scc1 L_pv1
    s_waitcnt vmcnt(7)
    v_mfma_f32_16x16x32_bf16 v[112:115], v[32:35], v[48:51], 0
    s_waitcnt vmcnt(6)
    v_mfma_f32_16x16x32_bf16 v[112:115], v[36:39], v[52:55], v[112:115]
    s_waitcnt vmcnt(5)
    v_mfma_f32_16x16x32_bf16 v[112:115], v[40:43], v[56:59], v[112:115]
    s_waitcnt vmcnt(4)
    v_mfma_f32_16x16x32_bf16 v[112:115], v[44:47], v[60:63], v[112:115]
    s_branch L_pvd
L_pv1:
    s_waitcnt vmcnt(3)
    v_mfma_f32_16x16x32_bf16 v[112:115], v[32:35], v[48:51], 0
    s_waitcnt vmcnt(2)
    v_mfma_f32_16x16x32_bf16 v[112:115], v[36:39], v[52:55], v[112:115]
    s_waitcnt vmcnt(1)
    v_mfma_f32_16x16x32_bf16 v[112:115], v[40:43], v[56:59], v[112:115]
    s_waitcnt vmcnt(0)
    v_mfma_f32_16x16x32_bf16 v[112:115], v[44:47], v[60:63], v[112:115]
L_pvd:
    s_nop 7
    ds_write_b128 v124, v[112:115] offset:12288
    s_waitcnt lgkmcnt(0)
    s_barrier
    s_cmp_ge_u32 s63, 144
    s_cbranch_scc1 L_sw
    s_lshl_b32 s12, s4, 14
    s_lshl_b32 s13, s3, 7
    s_add_u32 s12, s12, s13
    s_add_u32 s12, s12, 262144
    v_lshlrev_b32 v16, 11, v4
    v_lshl_or_b32 v16, v3, 4, v16
    v_add_u32 v16, s12, v16
    s_mov_b32 s60, 0
    v_mov_b32 v18, v16
    s_mov_b64 s[64:65], -1
    s_mov_b64 s[66:67], -1
L_pop:
    s_mov_b64 exec, s[64:65]
    global_load_dwordx4 v[32:35], v16, s[36:37] sc1
    s_mov_b64 exec, s[66:67]
    global_load_dwordx4 v[36:39], v16, s[36:37] offset:1024 sc1
    s_mov_b64 exec, -1
    s_add_u32 s60, s60, 1
    s_cmp_gt_u32 s60, 24
    s_cbranch_scc1 L_pop_f
    s_waitcnt vmcnt(1)
    v_xor_b32 v17, v35, v5
    v_cmp_ne_u32_e64 s[64:65], 0, v17
    s_waitcnt vmcnt(0)
    v_xor_b32 v17, v39, v5
    v_cmp_ne_u32_e64 s[66:67], 0, v17
    s_or_b64 s[72:73], s[64:65], s[66:67]
    s_cbranch_scc0 L_pop_x
    s_branch L_pop
L_pop_f:
    s_waitcnt vmcnt(1)
    v_xor_b32 v17, v35, v5
    v_cmp_ne_u32_e64 s[64:65], 0, v17
    s_waitcnt vmcnt(0)
    v_xor_b32 v17, v39, v5
    v_cmp_ne_u32_e64 s[66:67], 0, v17
    s_or_b64 s[72:73], s[64:65], s[66:67]
    s_cbranch_scc0 L_pop_x
    s_bitcmp1_b32 s60, 0
    s_cselect_b32 s61, 786432, 0
    v_xor_b32 v16, s61, v18
    s_mov_b64 exec, s[64:65]
    global_load_dwordx4 v[32:35], v16, s[36:37] sc1
    s_mov_b64 exec, s[66:67]
    global_load_dwordx4 v[36:39], v16, s[36:37] offset:1024 sc1
    s_mov_b64 exec, -1
    s_add_u32 s60, s60, 1
    s_cmp_gt_u32 s60, 100000
    s_cbranch_scc0 L_pop_f
L_pop_x:
    v_max_f32 v17, v34, v38
    v_mov_b32 v114, v34
    v_mov_b32 v118, v38
    v_lshlrev_b32 v20, 16, v32
    v_and_b32 v21, 0xffff0000, v32
    v_lshlrev_b32 v22, 16, v33
    v_and_b32 v23, 0xffff0000, v33
    v_lshlrev_b32 v24, 16, v36
    v_and_b32 v25, 0xffff0000, v36
    v_lshlrev_b32 v26, 16, v37
    v_and_b32 v27, 0xffff0000, v37
    v_max_f32_dpp v17, v17, v17 row_ror:8 row_mask:0xf bank_mask:0xf
    s_nop 1
    v_max_f32_dpp v17, v17, v17 row_ror:4 row_mask:0xf bank_mask:0xf
    s_nop 1
    v_max_f32_dpp v17, v17, v17 row_ror:2 row_mask:0xf bank_mask:0xf
    v_sub_f32 v114, v114, v17
    v_sub_f32 v118, v118, v17
    v_exp_f32 v114, v114
    v_exp_f32 v118, v118
    s_nop 0
    v_add_f32 v19, v114, v118
    v_mul_f32 v20, v20, v114
    v_mul_f32 v21, v21, v114
    v_mul_f32 v22, v22, v114
    v_mul_f32 v23, v23, v114
    v_fma_f32 v20, v24, v118, v20
    v_fma_f32 v21, v25, v118, v21
    v_fma_f32 v22, v26, v118, v22
    v_fma_f32 v23, v27, v118, v23
    v_add_f32_dpp v19, v19, v19 row_ror:8 row_mask:0xf bank_mask:0xf
    v_add_f32_dpp v20, v20, v20 row_ror:8 row_mask:0xf bank_mask:0xf
    v_add_f32_dpp v21, v21, v21 row_ror:8 row_mask:0xf bank_mask:0xf
    v_add_f32_dpp v22, v22, v22 row_ror:8 row_mask:0xf bank_mask:0xf
    v_add_f32_dpp v23, v23, v23 row_ror:8 row_mask:0xf bank_mask:0xf
    v_add_f32_dpp v19, v19, v19 row_ror:4 row_mask:0xf bank_mask:0xf
    v_add_f32_dpp v20, v20, v20 row_ror:4 row_mask:0xf bank_mask:0xf
    v_add_f32_dpp v21, v21, v21 row_ror:4 row_mask:0xf bank_mask:0xf
    v_add_f32_dpp v22, v22, v22 row_ror:4 row_mask:0xf bank_mask:0xf
    v_add_f32_dpp v23, v23, v23 row_ror:4 row_mask:0xf bank_mask:0xf
    v_add_f32_dpp v19, v19, v19 row_ror:2 row_mask:0xf bank_mask:0xf
    v_add_f32_dpp v20, v20, v20 row_ror:2 row_mask:0xf bank_mask:0xf
    v_add_f32_dpp v21, v21, v21 row_ror:2 row_mask:0xf bank_mask:0xf
    v_add_f32_dpp v22, v22, v22 row_ror:2 row_mask:0xf bank_mask:0xf
    v_add_f32_dpp v23, v23, v23 row_ror:2 row_mask:0xf bank_mask:0xf
    v_rcp_f32 v19, v19
    s_nop 0
    v_mul_f32 v20, v20, v19
    v_mul_f32 v21, v21, v19
    v_mul_f32 v22, v22, v19
    v_mul_f32 v23, v23, v19
    v_cvt_pk_bf16_f32 v20, v20, v20
    v_cvt_pk_bf16_f32 v21, v21, v21
    v_cvt_pk_bf16_f32 v22, v22, v22
    v_cvt_pk_bf16_f32 v23, v23, v23
    v_and_b32 v112, v20, v8
    v_and_b32 v113, v20, v9
    v_and_b32 v114, v20, v10
    v_and_b32 v115, v20, v11
    s_nop 1
    v_mfma_f32_16x16x32_bf16 v[24:27], v[112:115], v[64:67], 0
    v_and_b32 v116, v21, v8
    v_and_b32 v117, v21, v9
    v_and_b32 v118, v21, v10
    v_and_b32 v119, v21, v11
    s_nop 1
    v_mfma_f32_16x16x32_bf16 v[24:27], v[116:119], v[68:71], v[24:27]
    v_and_b32 v112, v22, v8
    v_and_b32 v113, v22, v9
    v_and_b32 v114, v22, v10
    v_and_b32 v115, v22, v11
    s_nop 1
    v_mfma_f32_16x16x32_bf16 v[24:27], v[112:115], v[72:75], v[24:27]
    v_and_b32 v116, v23, v8
    v_and_b32 v117, v23, v9
    v_and_b32 v118, v23, v10
    v_and_b32 v119, v23, v11
    s_nop 1
    v_mfma_f32_16x16x32_bf16 v[24:27], v[116:119], v[76:79], v[24:27]
    s_lshl_b32 s12, s3, 8
    v_lshlrev_b32 v16, 5, v2
    v_lshl_or_b32 v16, v1, 3, v16
    v_add_u32 v16, s12, v16
    s_nop 3
    v_add_f32_dpp v20, v25, v24 row_ror:8 row_mask:0xf bank_mask:0xf
    v_add_f32_dpp v21, v27, v26 row_ror:8 row_mask:0xf bank_mask:0xf
    s_mov_b32 exec_lo, 0x00ff00ff
    s_mov_b32 exec_hi, 0x00ff00ff
    ds_write_b64 v16, v[20:21] offset:3328
    s_mov_b64 exec, -1
    s_waitcnt lgkmcnt(0)
    s_barrier
    s_branch L_fin
L_nt:
    v_mov_b32 v112, 0
    v_mov_b32 v113, 0
    v_mov_b32 v114, 0
    v_mov_b32 v115, 0
    v_mov_b32 v116, 0xf149f2ca
    v_mov_b32 v117, 0
    s_lshl_b32 s12, s3, 10
    v_lshl_add_u32 v18, v0, 4, s12
    ds_write_b128 v18, v[112:115] offset:12288
    s_lshl_b32 s12, s3, 3
    v_lshl_add_u32 v18, v0, 7, s12
    s_mov_b64 exec, 3
    ds_write_b64 v18, v[116:117] offset:3072
    s_mov_b64 exec, -1
    s_waitcnt lgkmcnt(0)
    s_cmp_lt_u32 s2, 184
    s_cbranch_scc1 L_fin
    s_cmp_gt_u32 s3, 8
    s_cbranch_scc1 L_fin
    s_add_u32 s6, s6, 1
    v_mov_b32 v5, s6
    v_lshl_or_b32 v18, v2, 2, v1
    s_lshl_b32 s12, s3, 7
    v_lshl_add_u32 v18, v18, 1, s12
    global_load_ushort v126, v18, s[16:17]
    s_mov_b32 s12, 4608
    v_mul_lo_u32 v28, v7, s12
    v_lshl_add_u32 v29, v28, 3, v6
    v_add_u32 v28, v28, v6
    s_mul_i32 s12, s4, 294912
    s_mul_i32 s13, s3, 36864
    s_add_u32 s12, s12, s13
    s_min_u32 s38, s5, 8
    s_lshl_b32 s38, s38, 7
    s_add_u32 s14, s12, s38
    s_add_u32 s46, s24, s14
    s_addc_u32 s47, s25, 0
    s_mov_b32 s48, s28
    s_mov_b32 s49, s29
    s_mov_b32 s50, 5308416
    s_mov_b32 s51, 0x20000
    s_max_u32 s59, s2, 184
    s_sub_u32 s59, s59, 184
    s_mul_i32 s13, s3, 589824
    s_lshl_b32 s12, s59, 7
    s_add_u32 s56, s12, s13
    s_mul_i32 s12, s59, 73728
    s_lshl_b32 s13, s3, 7
    s_add_u32 s12, s12, s13
    s_add_u32 s52, s30, s12
    s_addc_u32 s53, s31, 0
    s_add_u32 s54, s52, 36864
    s_addc_u32 s55, s53, 0
    s_barrier
    buffer_load_dwordx4 v[128:131], v29, s[48:51], s56 offen nt
    s_add_u32 s56, s56, 9216
    buffer_load_dwordx4 v[132:135], v29, s[48:51], s56 offen nt
    s_add_u32 s56, s56, 9216
    buffer_load_dwordx4 v[136:139], v29, s[48:51], s56 offen nt
    s_add_u32 s56, s56, 9216
    s_barrier
    buffer_load_dwordx4 v[140:143], v29, s[48:51], s56 offen nt
    s_add_u32 s56, s56, 267264
    s_barrier
L_f1q:
    v_lshl_or_b32 v18, v2, 2, v1
    s_lshl_b32 s12, s3, 6
    v_add_u32 v19, s12, v18
    s_lshl_b32 s12, s3, 12
    s_add_u32 s12, s12, 786432
    v_lshlrev_b32 v16, 4, v0
    v_add_u32 v16, s12, v16
    v_lshlrev_b32 v19, 2, v19
    s_lshl_b32 s12, s3, 7
    v_and_b32 v30, 3, v0
    v_lshrrev_b32 v27, 2, v2
    v_and_b32 v22, 1, v1
    v_lshlrev_b32 v22, 3, v22
    v_and_b32 v23, 2, v1
    v_lshl_or_b32 v22, v23, 4, v22
    v_and_b32 v20, 1, v0
    v_lshlrev_b32 v20, 4, v20
    v_or_b32 v22, v22, v20
    v_and_b32 v23, 6, v0
    v_or_b32 v22, v22, v23
    v_and_b32 v23, 8, v0
    v_lshl_or_b32 v22, v23, 3, v22
    v_add_u32 v22, s12, v22
    v_add_u32 v18, s12, v20
    s_lshl_b32 s12, s3, 8
    v_lshl_or_b32 v23, v1, 7, v6
    v_add_u32 v23, s12, v23
    s_lshl_b32 s12, s3, 5
    v_lshl_add_u32 v14, v1, 3, s12
    v_lshl_add_u32 v8, v1, 1, v27
    s_mov_b32 s12, 4608
    v_mul_lo_u32 v8, v8, s12
    v_lshl_or_b32 v8, v30, 4, v8
    s_mul_i32 s12, s3, 18432
    s_lshl_b32 s13, s59, 6
    s_add_u32 s12, s12, s13
    s_add_u32 s12, s12, 917504
    v_add_u32 v8, s12, v8
    v_mov_b32 v112, 0
    v_mov_b32 v113, 0
    v_mov_b32 v116, 0
    v_mov_b32 v117, 0
    v_mov_b32 v114, 0x3f80
    v_mov_b32 v115, 0
    v_lshlrev_b32 v9, 4, v27
    v_lshlrev_b64 v[114:115], v9, v[114:115]
    v_cmp_eq_u32 vcc, v1, v30
    s_nop 1
    v_cndmask_b32 v114, 0, v114, vcc
    v_cndmask_b32 v115, 0, v115, vcc
    v_mov_b32 v9, 0x3f803f80
    v_cmp_eq_u32 vcc, v1, v4
    s_nop 1
    v_cndmask_b32 v120, 0, v9, vcc
    v_cndmask_b32 v121, 0, v9, vcc
    v_cndmask_b32 v122, 0, v9, vcc
    v_cndmask_b32 v123, 0, v9, vcc
    v_lshlrev_b32 v26, 3, v0
    s_mov_b64 exec, 0xfff
    ds_write_b64 v26, v[112:113] offset:5920
    s_mov_b64 exec, -1
    s_waitcnt vmcnt(3)
    buffer_load_dwordx4 v[144:147], v29, s[48:51], s56 offen nt
    s_add_u32 s56, s56, 9216
    v_mfma_f32_16x16x32_bf16 v[48:51], v[114:117], v[128:131], 0
    v_mfma_f32_16x16x32_bf16 v[56:59], v[112:115], v[128:131], 0
    s_waitcnt vmcnt(3)
    buffer_load_dwordx4 v[148:151], v29, s[48:51], s56 offen nt
    s_add_u32 s56, s56, 9216
    v_mfma_f32_16x16x32_bf16 v[52:55], v[114:117], v[132:135], 0
    v_mfma_f32_16x16x32_bf16 v[60:63], v[112:115], v[132:135], 0
    s_nop 1
    v_cvt_pk_bf16_f32 v128, v48, v49
    v_cvt_pk_bf16_f32 v129, v50, v51
    s_nop 2
    v_cvt_pk_bf16_f32 v130, v52, v53
    v_cvt_pk_bf16_f32 v131, v54, v55
    v_cvt_pk_bf16_f32 v132, v56, v57
    v_cvt_pk_bf16_f32 v133, v58, v59
    v_cvt_pk_bf16_f32 v134, v60, v61
    v_cvt_pk_bf16_f32 v135, v62, v63
    s_waitcnt vmcnt(3)
    buffer_load_dwordx4 v[152:155], v29, s[48:51], s56 offen nt
    s_add_u32 s56, s56, 9216
    v_mfma_f32_16x16x32_bf16 v[64:67], v[114:117], v[136:139], 0
    v_mfma_f32_16x16x32_bf16 v[72:75], v[112:115], v[136:139], 0
    s_waitcnt vmcnt(3)
    buffer_load_dwordx4 v[156:159], v29, s[48:51], s56 offen nt
    s_add_u32 s56, s56, 9216
    v_mfma_f32_16x16x32_bf16 v[68:71], v[114:117], v[140:143], 0
    v_mfma_f32_16x16x32_bf16 v[76:79], v[112:115], v[140:143], 0
    s_nop 1
    v_cvt_pk_bf16_f32 v136, v64, v65
    v_cvt_pk_bf16_f32 v137, v66, v67
    s_nop 2
    v_cvt_pk_bf16_f32 v138, v68, v69
    v_cvt_pk_bf16_f32 v139, v70, v71
    v_cvt_pk_bf16_f32 v140, v72, v73
    v_cvt_pk_bf16_f32 v141, v74, v75
    v_cvt_pk_bf16_f32 v142, v76, v77
    v_cvt_pk_bf16_f32 v143, v78, v79
    s_waitcnt vmcnt(3)
    global_load_dwordx4 v[80:83], v28, s[52:53] offset:0 nt
    v_mfma_f32_16x16x32_bf16 v[48:51], v[114:117], v[144:147], 0
    v_mfma_f32_16x16x32_bf16 v[56:59], v[112:115], v[144:147], 0
    s_waitcnt vmcnt(3)
    global_load_dwordx4 v[84:87], v28, s[52:53] offset:1152 nt
    v_mfma_f32_16x16x32_bf16 v[52:55], v[114:117], v[148:151], 0
    v_mfma_f32_16x16x32_bf16 v[60:63], v[112:115], v[148:151], 0
    s_nop 2
    v_cvt_pk_bf16_f32 v144, v48, v49
    v_cvt_pk_bf16_f32 v145, v50, v51
    s_nop 1
    v_cvt_pk_bf16_f32 v146, v52, v53
    v_cvt_pk_bf16_f32 v147, v54, v55
    v_cvt_pk_bf16_f32 v148, v56, v57
    v_cvt_pk_bf16_f32 v149, v58, v59
    v_cvt_pk_bf16_f32 v150, v60, v61
    v_cvt_pk_bf16_f32 v151, v62, v63
    s_waitcnt vmcnt(3)
    global_load_dwordx4 v[88:91], v28, s[52:53] offset:2304 nt
    v_mfma_f32_16x16x32_bf16 v[64:67], v[114:117], v[152:155], 0
    v_mfma_f32_16x16x32_bf16 v[72:75], v[112:115], v[152:155], 0
    s_waitcnt vmcnt(3)
    v_lshlrev_b32 v21, 16, v126
    global_load_dwordx4 v[92:95], v28, s[52:53] offset:3456 nt
    v_mfma_f32_16x16x32_bf16 v[68:71], v[114:117], v[156:159], 0
    v_mfma_f32_16x16x32_bf16 v[76:79], v[112:115], v[156:159], 0
    s_nop 1
    v_cvt_pk_bf16_f32 v152, v64, v65
    v_cvt_pk_bf16_f32 v153, v66, v67
    s_nop 2
    v_cvt_pk_bf16_f32 v154, v68, v69
    v_cvt_pk_bf16_f32 v155, v70, v71
    v_cvt_pk_bf16_f32 v156, v72, v73
    v_cvt_pk_bf16_f32 v157, v74, v75
    v_cvt_pk_bf16_f32 v158, v76, v77
    v_cvt_pk_bf16_f32 v159, v78, v79
    v_mfma_f32_16x16x32_bf16 v[24:27], v[120:123], v[128:131], 0
    v_mfma_f32_16x16x32_bf16 v[124:127], v[120:123], v[132:135], 0
    v_mfma_f32_16x16x32_bf16 v[24:27], v[120:123], v[136:139], v[24:27]
    v_mfma_f32_16x16x32_bf16 v[124:127], v[120:123], v[140:143], v[124:127]
    v_mfma_f32_16x16x32_bf16 v[24:27], v[120:123], v[144:147], v[24:27]
    v_mfma_f32_16x16x32_bf16 v[124:127], v[120:123], v[148:151], v[124:127]
    v_mfma_f32_16x16x32_bf16 v[24:27], v[120:123], v[152:155], v[24:27]
    v_mfma_f32_16x16x32_bf16 v[124:127], v[120:123], v[156:159], v[124:127]
    s_nop 6
    v_add_f32_dpp v10, v25, v24 row_ror:8 row_mask:0xf bank_mask:0xf
    v_add_f32_dpp v11, v27, v26 row_ror:8 row_mask:0xf bank_mask:0xf
    v_add_f32_dpp v12, v125, v124 row_ror:8 row_mask:0xf bank_mask:0xf
    v_add_f32_dpp v13, v127, v126 row_ror:8 row_mask:0xf bank_mask:0xf
    s_mov_b64 exec, 0x00ff00ff
    ds_write_b128 v23, v[10:13] offset:0
    s_mov_b64 exec, -1
    s_waitcnt vmcnt(3)
    global_load_dwordx4 v[96:99], v28, s[54:55] offset:0 nt
    v_mfma_f32_16x16x32_bf16 v[48:51], v[114:117], v[80:83], 0
    v_mfma_f32_16x16x32_bf16 v[56:59], v[112:115], v[80:83], 0
    s_waitcnt vmcnt(3)
    global_load_dwordx4 v[100:103], v28, s[54:55] offset:1152 nt
    v_mfma_f32_16x16x32_bf16 v[52:55], v[114:117], v[84:87], 0
    v_mfma_f32_16x16x32_bf16 v[60:63], v[112:115], v[84:87], 0
    s_nop 2
    v_cvt_pk_bf16_f32 v80, v48, v49
    v_cvt_pk_bf16_f32 v81, v50, v51
    s_nop 1
    v_cvt_pk_bf16_f32 v82, v52, v53
    v_cvt_pk_bf16_f32 v83, v54, v55
    v_cvt_pk_bf16_f32 v84, v56, v57
    v_cvt_pk_bf16_f32 v85, v58, v59
    v_cvt_pk_bf16_f32 v86, v60, v61
    v_cvt_pk_bf16_f32 v87, v62, v63
    s_waitcnt vmcnt(3)
    global_load_dwordx4 v[104:107], v28, s[54:55] offset:2304 nt
    v_mfma_f32_16x16x32_bf16 v[64:67], v[114:117], v[88:91], 0
    v_mfma_f32_16x16x32_bf16 v[72:75], v[112:115], v[88:91], 0
    s_waitcnt vmcnt(3)
    global_load_dwordx4 v[108:111], v28, s[54:55] offset:3456 nt
    v_mfma_f32_16x16x32_bf16 v[68:71], v[114:117], v[92:95], 0
    v_mfma_f32_16x16x32_bf16 v[76:79], v[112:115], v[92:95], 0
    s_nop 2
    v_cvt_pk_bf16_f32 v88, v64, v65
    v_cvt_pk_bf16_f32 v89, v66, v67
    s_nop 1
    v_cvt_pk_bf16_f32 v90, v68, v69
    v_cvt_pk_bf16_f32 v91, v70, v71
    v_cvt_pk_bf16_f32 v92, v72, v73
    v_cvt_pk_bf16_f32 v93, v74, v75
    v_cvt_pk_bf16_f32 v94, v76, v77
    v_cvt_pk_bf16_f32 v95, v78, v79
    s_waitcnt vmcnt(3)
    global_load_dwordx4 v[32:35], v16, s[36:37] offset:0 sc1
    global_load_dwordx4 v[36:39], v16, s[36:37] offset:1024 sc1
    global_load_dwordx4 v[40:43], v16, s[36:37] offset:2048 sc1
    global_load_dwordx4 v[44:47], v16, s[36:37] offset:3072 sc1
    v_mfma_f32_16x16x32_bf16 v[48:51], v[114:117], v[96:99], 0
    v_mfma_f32_16x16x32_bf16 v[56:59], v[112:115], v[96:99], 0
    s_waitcnt vmcnt(6)
    v_mfma_f32_16x16x32_bf16 v[52:55], v[114:117], v[100:103], 0
    v_mfma_f32_16x16x32_bf16 v[60:63], v[112:115], v[100:103], 0
    s_nop 3
    v_cvt_pk_bf16_f32 v96, v48, v49
    v_cvt_pk_bf16_f32 v97, v50, v51
    s_nop 0
    v_cvt_pk_bf16_f32 v98, v52, v53
    v_cvt_pk_bf16_f32 v99, v54, v55
    v_cvt_pk_bf16_f32 v100, v56, v57
    v_cvt_pk_bf16_f32 v101, v58, v59
    v_cvt_pk_bf16_f32 v102, v60, v61
    v_cvt_pk_bf16_f32 v103, v62, v63
    s_waitcnt vmcnt(5)
    v_mfma_f32_16x16x32_bf16 v[64:67], v[114:117], v[104:107], 0
    v_mfma_f32_16x16x32_bf16 v[72:75], v[112:115], v[104:107], 0
    s_waitcnt vmcnt(4)
    v_mfma_f32_16x16x32_bf16 v[68:71], v[114:117], v[108:111], 0
    v_mfma_f32_16x16x32_bf16 v[76:79], v[112:115], v[108:111], 0
    s_nop 3
    v_cvt_pk_bf16_f32 v104, v64, v65
    v_cvt_pk_bf16_f32 v105, v66, v67
    s_nop 0
    v_cvt_pk_bf16_f32 v106, v68, v69
    v_cvt_pk_bf16_f32 v107, v70, v71
    v_cvt_pk_bf16_f32 v108, v72, v73
    v_cvt_pk_bf16_f32 v109, v74, v75
    v_cvt_pk_bf16_f32 v110, v76, v77
    v_cvt_pk_bf16_f32 v111, v78, v79
    v_mov_b32 v64, 0
    v_mov_b32 v65, 0
    v_mov_b32 v66, 0
    v_mov_b32 v67, 0
    v_mov_b32 v68, 0
    v_mov_b32 v69, 0
    v_mov_b32 v70, 0
    v_mov_b32 v71, 0
    v_mov_b32 v72, 0
    v_mov_b32 v73, 0
    v_mov_b32 v74, 0
    v_mov_b32 v75, 0
    v_mov_b32 v76, 0
    v_mov_b32 v77, 0
    v_mov_b32 v78, 0
    v_mov_b32 v79, 0
    s_mov_b32 s60, 0
    s_waitcnt vmcnt(3)
    v_xor_b32 v17, v32, v5
    v_bitop3_b32 v17, v17, v33, v5 bitop3:0xf6
    v_bitop3_b32 v17, v17, v34, v5 bitop3:0xf6
    v_bitop3_b32 v17, v17, v35, v5 bitop3:0xf6
    v_and_b32 v17, s7, v17
    v_cmp_ne_u32_e64 s[64:65], 0, v17
    s_waitcnt vmcnt(2)
    v_xor_b32 v17, v36, v5
    v_bitop3_b32 v17, v17, v37, v5 bitop3:0xf6
    v_bitop3_b32 v17, v17, v38, v5 bitop3:0xf6
    v_bitop3_b32 v17, v17, v39, v5 bitop3:0xf6
    v_and_b32 v17, s7, v17
    v_cmp_ne_u32_e64 s[66:67], 0, v17
    s_waitcnt vmcnt(1)
    v_xor_b32 v17, v40, v5
    v_bitop3_b32 v17, v17, v41, v5 bitop3:0xf6
    v_bitop3_b32 v17, v17, v42, v5 bitop3:0xf6
    v_bitop3_b32 v17, v17, v43, v5 bitop3:0xf6
    v_and_b32 v17, s7, v17
    v_cmp_ne_u32_e64 s[68:69], 0, v17
    s_waitcnt vmcnt(0)
    v_xor_b32 v17, v44, v5
    v_bitop3_b32 v17, v17, v45, v5 bitop3:0xf6
    v_bitop3_b32 v17, v17, v46, v5 bitop3:0xf6
    v_bitop3_b32 v17, v17, v47, v5 bitop3:0xf6
    v_and_b32 v17, s7, v17
    v_cmp_ne_u32_e64 s[70:71], 0, v17
    s_or_b64 s[72:73], s[64:65], s[66:67]
    s_or_b64 s[72:73], s[72:73], s[68:69]
    s_or_b64 s[72:73], s[72:73], s[70:71]
    s_cbranch_scc0 L_pap_x
L_pap_g:
    s_sleep 10
    s_mov_b64 exec, s[64:65]
    global_load_dwordx4 v[32:35], v16, s[36:37] offset:0 sc1
    s_mov_b64 exec, s[66:67]
    global_load_dwordx4 v[36:39], v16, s[36:37] offset:1024 sc1
    s_mov_b64 exec, s[68:69]
    global_load_dwordx4 v[40:43], v16, s[36:37] offset:2048 sc1
    s_mov_b64 exec, s[70:71]
    global_load_dwordx4 v[44:47], v16, s[36:37] offset:3072 sc1
    s_mov_b64 exec, -1
    s_add_u32 s60, s60, 1
    s_cmp_gt_u32 s60, 100000
    s_cbranch_scc1 L_pap_x
L_pap_gc:
    s_waitcnt vmcnt(3)
    v_xor_b32 v17, v32, v5
    v_bitop3_b32 v17, v17, v33, v5 bitop3:0xf6
    v_bitop3_b32 v17, v17, v34, v5 bitop3:0xf6
    v_bitop3_b32 v17, v17, v35, v5 bitop3:0xf6
    v_and_b32 v17, s7, v17
    v_cmp_ne_u32_e64 s[64:65], 0, v17
    s_waitcnt vmcnt(2)
    v_xor_b32 v17, v36, v5
    v_bitop3_b32 v17, v17, v37, v5 bitop3:0xf6
    v_bitop3_b32 v17, v17, v38, v5 bitop3:0xf6
    v_bitop3_b32 v17, v17, v39, v5 bitop3:0xf6
    v_and_b32 v17, s7, v17
    v_cmp_ne_u32_e64 s[66:67], 0, v17
    s_waitcnt vmcnt(1)
    v_xor_b32 v17, v40, v5
    v_bitop3_b32 v17, v17, v41, v5 bitop3:0xf6
    v_bitop3_b32 v17, v17, v42, v5 bitop3:0xf6
    v_bitop3_b32 v17, v17, v43, v5 bitop3:0xf6
    v_and_b32 v17, s7, v17
    v_cmp_ne_u32_e64 s[68:69], 0, v17
    s_waitcnt vmcnt(0)
    v_xor_b32 v17, v44, v5
    v_bitop3_b32 v17, v17, v45, v5 bitop3:0xf6
    v_bitop3_b32 v17, v17, v46, v5 bitop3:0xf6
    v_bitop3_b32 v17, v17, v47, v5 bitop3:0xf6
    v_and_b32 v17, s7, v17
    v_cmp_ne_u32_e64 s[70:71], 0, v17
    s_or_b64 s[72:73], s[64:65], s[66:67]
    s_or_b64 s[72:73], s[72:73], s[68:69]
    s_or_b64 s[72:73], s[72:73], s[70:71]
    s_cbranch_scc0 L_pap_x
    s_bcnt1_i32_b64 s74, s[64:65]
    s_bcnt1_i32_b64 s75, s[66:67]
    s_add_u32 s74, s74, s75
    s_bcnt1_i32_b64 s75, s[68:69]
    s_add_u32 s74, s74, s75
    s_bcnt1_i32_b64 s75, s[70:71]
    s_add_u32 s74, s74, s75
    s_cmp_gt_u32 s74, 96
    s_cbranch_scc1 L_pap_g
    s_mov_b64 exec, s[64:65]
    global_load_dwordx4 v[32:35], v16, s[36:37] offset:0 sc1
    s_mov_b64 exec, s[66:67]
    global_load_dwordx4 v[36:39], v16, s[36:37] offset:1024 sc1
    s_mov_b64 exec, s[68:69]
    global_load_dwordx4 v[40:43], v16, s[36:37] offset:2048 sc1
    s_mov_b64 exec, s[70:71]
    global_load_dwordx4 v[44:47], v16, s[36:37] offset:3072 sc1
    s_mov_b64 exec, -1
    s_sleep 5
    s_mov_b64 exec, s[64:65]
    global_load_dwordx4 v[32:35], v16, s[36:37] offset:0 sc1
    s_mov_b64 exec, s[66:67]
    global_load_dwordx4 v[36:39], v16, s[36:37] offset:1024 sc1
    s_mov_b64 exec, s[68:69]
    global_load_dwordx4 v[40:43], v16, s[36:37] offset:2048 sc1
    s_mov_b64 exec, s[70:71]
    global_load_dwordx4 v[44:47], v16, s[36:37] offset:3072 sc1
    s_mov_b64 exec, -1
    s_sleep 5
L_pap:
    s_mov_b64 exec, s[64:65]
    global_load_dwordx4 v[32:35], v16, s[36:37] offset:0 sc1
    s_mov_b64 exec, s[66:67]
    global_load_dwordx4 v[36:39], v16, s[36:37] offset:1024 sc1
    s_mov_b64 exec, s[68:69]
    global_load_dwordx4 v[40:43], v16, s[36:37] offset:2048 sc1
    s_mov_b64 exec, s[70:71]
    global_load_dwordx4 v[44:47], v16, s[36:37] offset:3072 sc1
    s_mov_b64 exec, -1
    s_add_u32 s60, s60, 1
    s_cmp_gt_u32 s60, 100000
    s_cbranch_scc1 L_pap_x
    s_waitcnt vmcnt(11)
    v_xor_b32 v17, v32, v5
    v_bitop3_b32 v17, v17, v33, v5 bitop3:0xf6
    v_bitop3_b32 v17, v17, v34, v5 bitop3:0xf6
    v_bitop3_b32 v17, v17, v35, v5 bitop3:0xf6
    v_and_b32 v17, s7, v17
    v_cmp_ne_u32_e64 s[64:65], 0, v17
    s_waitcnt vmcnt(10)
    v_xor_b32 v17, v36, v5
    v_bitop3_b32 v17, v17, v37, v5 bitop3:0xf6
    v_bitop3_b32 v17, v17, v38, v5 bitop3:0xf6
    v_bitop3_b32 v17, v17, v39, v5 bitop3:0xf6
    v_and_b32 v17, s7, v17
    v_cmp_ne_u32_e64 s[66:67], 0, v17
    s_waitcnt vmcnt(9)
    v_xor_b32 v17, v40, v5
    v_bitop3_b32 v17, v17, v41, v5 bitop3:0xf6
    v_bitop3_b32 v17, v17, v42, v5 bitop3:0xf6
    v_bitop3_b32 v17, v17, v43, v5 bitop3:0xf6
    v_and_b32 v17, s7, v17
    v_cmp_ne_u32_e64 s[68:69], 0, v17
    s_waitcnt vmcnt(8)
    v_xor_b32 v17, v44, v5
    v_bitop3_b32 v17, v17, v45, v5 bitop3:0xf6
    v_bitop3_b32 v17, v17, v46, v5 bitop3:0xf6
    v_bitop3_b32 v17, v17, v47, v5 bitop3:0xf6
    v_and_b32 v17, s7, v17
    v_cmp_ne_u32_e64 s[70:71], 0, v17
    s_or_b64 s[72:73], s[64:65], s[66:67]
    s_or_b64 s[72:73], s[72:73], s[68:69]
    s_or_b64 s[72:73], s[72:73], s[70:71]
    s_cbranch_scc0 L_pap_x
    s_branch L_pap
L_pap_x:
    v_pk_add_f32 v[48:49], v[32:33], v[36:37]
    v_pk_add_f32 v[50:51], v[34:35], v[38:39]
    v_pk_add_f32 v[52:53], v[40:41], v[44:45]
    v_pk_add_f32 v[54:55], v[42:43], v[46:47]
    v_pk_add_f32 v[48:49], v[48:49], v[52:53]
    v_pk_add_f32 v[50:51], v[50:51], v[54:55]
    s_nop 1
    v_permlane32_swap_b32 v48, v50
    v_permlane32_swap_b32 v49, v51
    v_add_f32 v48, v48, v50
    v_add_f32 v49, v49, v51
    s_nop 1
    v_permlane16_swap_b32 v48, v49
    v_add_f32 v48, v48, v49
    v_cvt_pk_bf16_f32 v48, v48, v48
    v_and_b32 v48, 0xffff0000, v48
    v_add_f32 v48, v48, v21
    v_cvt_pk_bf16_f32 v48, v48, v48
    ds_write_b16 v22, v48 offset:9728
    v_and_b32 v50, 0xffff0000, v48
    s_mov_b32 exec_lo, 0x000c0003
    s_mov_b32 exec_hi, 0x00c00030
    ds_read_b128 v[64:67], v18 offset:9728
    ds_read_b128 v[68:71], v18 offset:9760
    ds_read_b128 v[72:75], v18 offset:9792
    ds_read_b128 v[76:79], v18 offset:9824
    s_mov_b64 exec, -1
    v_mul_f32 v51, v50, v50
    ds_write_b32 v19, v50 offset:7168
    v_add_f32_dpp v50, v50, v50 row_ror:8 row_mask:0xf bank_mask:0xf
    v_add_f32_dpp v51, v51, v51 row_ror:8 row_mask:0xf bank_mask:0xf
    s_nop 0
    v_add_f32_dpp v50, v50, v50 row_ror:4 row_mask:0xf bank_mask:0xf
    v_add_f32_dpp v51, v51, v51 row_ror:4 row_mask:0xf bank_mask:0xf
    s_nop 0
    v_add_f32_dpp v50, v50, v50 row_ror:2 row_mask:0xf bank_mask:0xf
    v_add_f32_dpp v51, v51, v51 row_ror:2 row_mask:0xf bank_mask:0xf
    s_nop 0
    v_add_f32_dpp v50, v50, v50 row_ror:1 row_mask:0xf bank_mask:0xf
    v_add_f32_dpp v51, v51, v51 row_ror:1 row_mask:0xf bank_mask:0xf
    s_mov_b32 exec_lo, 0x00010001
    s_mov_b32 exec_hi, 0x00010001
    ds_write_b64 v14, v[50:51] offset:5632
    s_mov_b64 exec, -1
    s_waitcnt lgkmcnt(2)
    v_mfma_f32_16x16x32_bf16 v[24:27], v[64:67], v[128:131], 0
    v_mfma_f32_16x16x32_bf16 v[124:127], v[64:67], v[132:135], 0
    v_mfma_f32_16x16x32_bf16 v[24:27], v[68:71], v[136:139], v[24:27]
    v_mfma_f32_16x16x32_bf16 v[124:127], v[68:71], v[140:143], v[124:127]
    v_mfma_f32_16x16x32_bf16 v[24:27], v[72:75], v[144:147], v[24:27]
    v_mfma_f32_16x16x32_bf16 v[124:127], v[72:75], v[148:151], v[124:127]
    v_mfma_f32_16x16x32_bf16 v[24:27], v[76:79], v[152:155], v[24:27]
    v_mfma_f32_16x16x32_bf16 v[124:127], v[76:79], v[156:159], v[124:127]
    s_nop 6
    v_add_f32_dpp v10, v25, v24 row_ror:8 row_mask:0xf bank_mask:0xf
    v_add_f32_dpp v11, v27, v26 row_ror:8 row_mask:0xf bank_mask:0xf
    v_add_f32_dpp v12, v125, v124 row_ror:8 row_mask:0xf bank_mask:0xf
    v_add_f32_dpp v13, v127, v126 row_ror:8 row_mask:0xf bank_mask:0xf
    s_mov_b64 exec, 0x00ff00ff
    ds_write_b128 v23, v[10:13] offset:3328
    s_mov_b64 exec, -1
    s_waitcnt lgkmcnt(0)
    s_barrier

    s_mov_b32 exec_lo, 0x000c0003
    s_mov_b32 exec_hi, 0x00c00030
    s_barrier
    ds_read_b128 v[64:67], v20 offset:6912
    ds_read_b128 v[68:71], v20 offset:6944
    ds_read_b128 v[72:75], v20 offset:6976
    ds_read_b128 v[76:79], v20 offset:7008
    s_mov_b64 exec, -1
    s_waitcnt lgkmcnt(3)
    v_mfma_f32_16x16x32_bf16 v[24:27], v[64:67], v[80:83], 0
    v_mfma_f32_16x16x32_bf16 v[124:127], v[64:67], v[84:87], 0
    s_waitcnt lgkmcnt(2)
    v_mfma_f32_16x16x32_bf16 v[24:27], v[68:71], v[88:91], v[24:27]
    v_mfma_f32_16x16x32_bf16 v[124:127], v[68:71], v[92:95], v[124:127]
    s_waitcnt lgkmcnt(1)
    v_mfma_f32_16x16x32_bf16 v[24:27], v[72:75], v[96:99], v[24:27]
    v_mfma_f32_16x16x32_bf16 v[124:127], v[72:75], v[100:103], v[124:127]
    s_waitcnt lgkmcnt(0)
    v_mfma_f32_16x16x32_bf16 v[24:27], v[76:79], v[104:107], v[24:27]
    v_mfma_f32_16x16x32_bf16 v[124:127], v[76:79], v[108:111], v[124:127]
    s_nop 6
    v_add_f32_dpp v20, v25, v24 row_ror:8 row_mask:0xf bank_mask:0xf
    v_add_f32_dpp v21, v27, v26 row_ror:8 row_mask:0xf bank_mask:0xf
    v_add_f32_dpp v22, v125, v124 row_ror:8 row_mask:0xf bank_mask:0xf
    v_add_f32_dpp v23, v127, v126 row_ror:8 row_mask:0xf bank_mask:0xf
    v_bfi_b32 v20, s7, v5, v20
    v_bfi_b32 v21, s7, v5, v21
    v_bfi_b32 v22, s7, v5, v22
    v_bfi_b32 v23, s7, v5, v23
    s_mov_b64 exec, 0x00ff00ff
    global_store_dwordx4 v8, v[20:23], s[36:37] sc1
    s_mov_b64 exec, -1
    s_mov_b32 s14, s59
    s_cmp_ge_u32 s14, 36
    s_cbranch_scc1 L_fs7
    s_cmp_ge_u32 s3, 1
    s_cbranch_scc1 L_fs7
    s_mul_i32 s12, s14, 4608
    s_add_u32 s12, s12, 917504
    v_lshlrev_b32 v16, 4, v0
    v_and_b32 v18, 0x1ff, v16
    v_add_u32 v16, s12, v16
    s_add_u32 s12, s12, 0x1000
    v_add_u32 v18, s12, v18
    s_lshr_b32 s12, s14, 2
    s_lshl_b32 s12, s12, 6
    s_and_b32 s13, s14, 1
    s_lshl_b32 s13, s13, 5
    s_add_u32 s12, s12, s13
    s_and_b32 s13, s14, 2
    s_add_u32 s12, s12, s13
    v_and_b32 v24, 3, v0
    v_lshlrev_b32 v24, 3, v24
    v_and_b32 v25, 1, v1
    v_or_b32 v24, v24, v25
    v_and_b32 v25, 2, v1
    v_lshl_or_b32 v24, v25, 1, v24
    v_add_u32 v24, s12, v24
    v_lshlrev_b32 v25, 2, v24
    v_lshlrev_b32 v24, 1, v24
    ds_read_b32 v26, v25 offset:7168
    s_mov_b32 s60, 0
    s_mov_b64 s[64:65], -1
    s_mov_b64 s[66:67], -1
    s_mov_b64 s[68:69], -1
    global_load_dwordx4 v[32:35], v16, s[36:37] offset:0 sc1
    global_load_dwordx4 v[36:39], v16, s[36:37] offset:1024 sc1
    global_load_dwordx4 v[40:43], v16, s[36:37] offset:2048 sc1
    global_load_dwordx4 v[44:47], v16, s[36:37] offset:3072 sc1
    global_load_dwordx4 v[48:51], v18, s[36:37] offset:0 sc1
    s_sleep 5
    global_load_dwordx4 v[32:35], v16, s[36:37] offset:0 sc1
    global_load_dwordx4 v[36:39], v16, s[36:37] offset:1024 sc1
    global_load_dwordx4 v[40:43], v16, s[36:37] offset:2048 sc1
    global_load_dwordx4 v[44:47], v16, s[36:37] offset:3072 sc1
    global_load_dwordx4 v[48:51], v18, s[36:37] offset:0 sc1
    s_sleep 5
L_pfp:
    s_mov_b64 exec, s[64:65]
    global_load_dwordx4 v[32:35], v16, s[36:37] offset:0 sc1
    global_load_dwordx4 v[36:39], v16, s[36:37] offset:1024 sc1
    s_mov_b64 exec, s[66:67]
    global_load_dwordx4 v[40:43], v16, s[36:37] offset:2048 sc1
    global_load_dwordx4 v[44:47], v16, s[36:37] offset:3072 sc1
    s_mov_b64 exec, s[68:69]
    global_load_dwordx4 v[48:51], v18, s[36:37] offset:0 sc1
    s_mov_b64 exec, -1
    s_add_u32 s60, s60, 1
    s_cmp_gt_u32 s60, 100000
    s_cbranch_scc1 L_pfp_x
    s_waitcnt vmcnt(13)
    v_xor_b32 v17, v32, v5
    v_bitop3_b32 v17, v17, v33, v5 bitop3:0xf6
    v_bitop3_b32 v17, v17, v34, v5 bitop3:0xf6
    v_bitop3_b32 v17, v17, v35, v5 bitop3:0xf6
    v_bitop3_b32 v17, v17, v36, v5 bitop3:0xf6
    v_bitop3_b32 v17, v17, v37, v5 bitop3:0xf6
    v_bitop3_b32 v17, v17, v38, v5 bitop3:0xf6
    v_bitop3_b32 v17, v17, v39, v5 bitop3:0xf6
    v_and_b32 v17, s7, v17
    v_cmp_ne_u32_e64 s[64:65], 0, v17
    s_waitcnt vmcnt(11)
    v_xor_b32 v17, v40, v5
    v_bitop3_b32 v17, v17, v41, v5 bitop3:0xf6
    v_bitop3_b32 v17, v17, v42, v5 bitop3:0xf6
    v_bitop3_b32 v17, v17, v43, v5 bitop3:0xf6
    v_bitop3_b32 v17, v17, v44, v5 bitop3:0xf6
    v_bitop3_b32 v17, v17, v45, v5 bitop3:0xf6
    v_bitop3_b32 v17, v17, v46, v5 bitop3:0xf6
    v_bitop3_b32 v17, v17, v47, v5 bitop3:0xf6
    v_and_b32 v17, s7, v17
    v_cmp_ne_u32_e64 s[66:67], 0, v17
    s_waitcnt vmcnt(10)
    v_xor_b32 v17, v48, v5
    v_bitop3_b32 v17, v17, v49, v5 bitop3:0xf6
    v_bitop3_b32 v17, v17, v50, v5 bitop3:0xf6
    v_bitop3_b32 v17, v17, v51, v5 bitop3:0xf6
    v_and_b32 v17, s7, v17
    v_cmp_ne_u32_e64 s[68:69], 0, v17
    s_or_b64 s[72:73], s[64:65], s[66:67]
    s_or_b64 s[72:73], s[72:73], s[68:69]
    s_cbranch_scc0 L_pfp_x
    s_branch L_pfp
L_pfp_x:
    v_pk_add_f32 v[68:69], v[32:33], v[36:37]
    v_pk_add_f32 v[70:71], v[34:35], v[38:39]
    v_pk_add_f32 v[72:73], v[40:41], v[44:45]
    v_pk_add_f32 v[74:75], v[42:43], v[46:47]
    s_mov_b32 exec_hi, 0
    v_pk_add_f32 v[72:73], v[72:73], v[48:49]
    v_pk_add_f32 v[74:75], v[74:75], v[50:51]
    s_mov_b32 exec_hi, -1
    v_pk_add_f32 v[68:69], v[68:69], v[72:73]
    v_pk_add_f32 v[70:71], v[70:71], v[74:75]
    s_nop 1
    v_permlane32_swap_b32 v68, v70
    v_permlane32_swap_b32 v69, v71
    v_add_f32 v68, v68, v70
    v_add_f32 v69, v69, v71
    s_nop 1
    v_permlane16_swap_b32 v68, v69
    v_add_f32 v68, v68, v69
    s_nop 1
    v_add_f32_dpp v68, v68, v68 row_ror:4 row_mask:0xf bank_mask:0xf
    s_nop 1
    v_add_f32_dpp v68, v68, v68 row_ror:8 row_mask:0xf bank_mask:0xf
    v_cvt_pk_bf16_f32 v68, v68, v68
    v_and_b32 v68, 0xffff0000, v68
    s_waitcnt lgkmcnt(0)
    v_add_f32 v68, v68, v26
    v_cvt_pk_bf16_f32 v68, v68, v68
    s_mov_b32 exec_lo, 0x000f000f
    s_mov_b32 exec_hi, 0x000f000f
    global_store_short v24, v68, s[32:33]
    s_cmp_lg_u32 s2, 184
    s_cbranch_scc1 L_fo
    s_mov_b64 exec, 1
    v_mov_b32 v69, 0
    global_store_dword v69, v5, s[36:37]

L_fo:
    s_mov_b64 exec, -1
L_fs7:
    s_branch L_fin
L_sw:
    s_cmp_lt_u32 s2, 184
    s_cbranch_scc1 L_fin
    s_cmp_lg_u32 s3, 9
    s_cbranch_scc1 L_fin
    s_setprio 3
    v_lshlrev_b32 v12, 2, v0
    v_lshlrev_b32 v14, 3, v2
    v_and_b32 v15, 3, v0
    v_lshlrev_b32 v15, 3, v15
    v_and_b32 v9, 32, v0
    v_or_b32 v15, v15, v9
    v_lshrrev_b32 v9, 2, v2
    v_lshl_or_b32 v15, v9, 1, v15
    v_and_b32 v9, 16, v0
    v_lshl_or_b32 v15, v9, 2, v15
    s_mov_b32 s12, 0x3ae38e39
    s_mov_b32 s13, 0x3727c5ac
    s_mov_b32 s14, 1069066811
    s_barrier
    ds_read_b64 v[54:55], v14 offset:5632
    ds_read_b64 v[56:57], v14 offset:5760
    ds_read_b64 v[58:59], v14 offset:5888
    ds_read2st64_b32 v[112:113], v12 offset0:13 offset1:14
    ds_read2st64_b32 v[114:115], v12 offset0:15 offset1:16
    ds_read2st64_b32 v[116:117], v12 offset0:17 offset1:18
    ds_read2st64_b32 v[118:119], v12 offset0:19 offset1:20
    ds_read_b32 v120, v12 offset:5376
    ds_read2st64_b32 v[64:65], v12 offset0:0 offset1:1
    ds_read2st64_b32 v[66:67], v12 offset0:2 offset1:3
    ds_read2st64_b32 v[68:69], v12 offset0:4 offset1:5
    ds_read2st64_b32 v[70:71], v12 offset0:6 offset1:7
    ds_read_b32 v72, v12 offset:2048
    s_waitcnt lgkmcnt(11)
    v_pk_add_f32 v[54:55], v[54:55], v[56:57]
    s_waitcnt lgkmcnt(10)
    v_pk_add_f32 v[54:55], v[54:55], v[58:59]
    s_nop 1
    v_add_f32_dpp v54, v54, v54 row_ror:8 row_mask:0xf bank_mask:0xf
    v_add_f32_dpp v55, v55, v55 row_ror:8 row_mask:0xf bank_mask:0xf
    s_nop 0
    v_add_f32_dpp v54, v54, v54 row_ror:4 row_mask:0xf bank_mask:0xf
    v_add_f32_dpp v55, v55, v55 row_ror:4 row_mask:0xf bank_mask:0xf
    s_nop 0
    v_add_f32_dpp v54, v54, v54 row_ror:2 row_mask:0xf bank_mask:0xf
    v_add_f32_dpp v55, v55, v55 row_ror:2 row_mask:0xf bank_mask:0xf
    s_nop 0
    v_add_f32_dpp v54, v54, v54 row_ror:1 row_mask:0xf bank_mask:0xf
    v_add_f32_dpp v55, v55, v55 row_ror:1 row_mask:0xf bank_mask:0xf
    v_mul_f32 v54, s12, v54
    v_mul_f32 v55, s12, v55
    v_fma_f32 v55, -v54, v54, v55
    v_max_f32 v55, 0, v55
    v_cvt_pk_bf16_f32 v55, v54, v55
    v_lshlrev_b32 v54, 16, v55
    v_and_b32 v55, 0xffff0000, v55
    v_add_f32 v55, s13, v55
    v_cvt_pk_bf16_f32 v55, v55, v55
    v_and_b32 v55, 0xffff0000, v55
    v_sqrt_f32 v55, v55
    s_waitcnt lgkmcnt(0)
    v_pk_add_f32 v[112:113], v[112:113], v[114:115]
    v_pk_add_f32 v[116:117], v[116:117], v[118:119]
    v_pk_add_f32 v[112:113], v[112:113], v[116:117]
    v_add_f32 v112, v112, v120
    v_add_f32 v112, v112, v113
    v_pk_add_f32 v[64:65], v[64:65], v[66:67]
    v_pk_add_f32 v[68:69], v[68:69], v[70:71]
    v_pk_add_f32 v[64:65], v[64:65], v[68:69]
    v_add_f32 v64, v64, v72
    v_add_f32 v64, v64, v65
    v_cvt_pk_bf16_f32 v55, v55, v55
    v_and_b32 v55, 0xffff0000, v55
    v_rcp_f32 v55, v55
    v_fma_f32 v48, -v54, v64, v112
    v_mul_f32 v48, v48, v55
    v_cvt_pk_bf16_f32 v48, v48, v48
    v_and_b32 v48, 0xffff0000, v48
    v_mul_f32 v49, s14, v48
    v_exp_f32 v49, -v49
    s_nop 0
    v_add_f32 v49, 1.0, v49
    v_rcp_f32 v49, v49
    s_nop 0
    v_mul_f32 v48, v48, v49
    v_cvt_pk_bf16_f32 v48, v48, v48
    ds_write_b16 v15, v48 offset:6912
    s_waitcnt lgkmcnt(0)
    s_barrier
    s_branch L_fin
L_q:
    s_setprio 3
    v_lshlrev_b32 v21, 4, v0
    v_lshlrev_b32 v22, 1, v0
    v_lshlrev_b32 v23, 17, v7
    v_or_b32 v23, v23, v6
    v_lshlrev_b32 v24, 14, v7
    v_add_u32 v24, 0x100000, v24
    v_or_b32 v24, v24, v6
    s_lshr_b32 s8, s5, 2
    s_and_b32 s9, s5, 3
    s_mul_i32 s10, s8, 1179648
    s_lshl_b32 s11, s4, 9
    s_add_u32 s10, s10, s11
    s_lshl_b32 s11, s9, 7
    s_add_u32 s10, s10, s11
    s_mov_b32 s42, 4718592
    s_mov_b32 s43, 0x20000
    s_mov_b32 s11, s10
    s_waitcnt lgkmcnt(0)
    global_load_dwordx4 v[16:19], v21, s[16:17]
    global_load_ushort v20, v22, s[16:17] offset:1024
    s_mov_b32 s40, s22
    s_mov_b32 s41, s23
    buffer_load_dwordx4 v[32:35], v23, s[40:43], s10 offen nt
    s_add_u32 s10, s10, 8192
    buffer_load_dwordx4 v[36:39], v23, s[40:43], s10 offen nt
    s_add_u32 s10, s10, 8192
    buffer_load_dwordx4 v[40:43], v23, s[40:43], s10 offen nt
    s_add_u32 s10, s10, 8192
    buffer_load_dwordx4 v[44:47], v23, s[40:43], s10 offen nt
    s_add_u32 s10, s10, 8192
    buffer_load_dwordx4 v[48:51], v23, s[40:43], s10 offen nt
    s_add_u32 s10, s10, 8192
    buffer_load_dwordx4 v[52:55], v23, s[40:43], s10 offen nt
    s_add_u32 s10, s10, 8192
    buffer_load_dwordx4 v[56:59], v23, s[40:43], s10 offen nt
    s_add_u32 s10, s10, 8192
    buffer_load_dwordx4 v[60:63], v23, s[40:43], s10 offen nt
    s_add_u32 s10, s10, 8192
    buffer_load_dwordx4 v[64:67], v23, s[40:43], s10 offen nt
    s_add_u32 s10, s10, 8192
    buffer_load_dwordx4 v[68:71], v23, s[40:43], s10 offen nt
    s_add_u32 s10, s10, 8192
    buffer_load_dwordx4 v[72:75], v23, s[40:43], s10 offen nt
    s_add_u32 s10, s10, 8192
    buffer_load_dwordx4 v[76:79], v23, s[40:43], s10 offen nt
    s_add_u32 s10, s10, 8192
    buffer_load_dwordx4 v[80:83], v23, s[40:43], s10 offen nt
    s_add_u32 s10, s10, 8192
    buffer_load_dwordx4 v[84:87], v23, s[40:43], s10 offen nt
    s_add_u32 s10, s10, 8192
    buffer_load_dwordx4 v[88:91], v23, s[40:43], s10 offen nt
    s_add_u32 s10, s10, 8192
    buffer_load_dwordx4 v[92:95], v23, s[40:43], s10 offen nt
    s_add_u32 s10, s10, 8192
    buffer_load_dwordx4 v[96:99], v24, s[40:43], s11 offen nt
    s_add_u32 s11, s11, 8192
    buffer_load_dwordx4 v[100:103], v24, s[40:43], s11 offen nt
    s_load_dword s6, s[36:37], 0
    s_barrier
    v_and_b32 v25, 3, v4
    v_lshlrev_b32 v25, 4, v25
    v_mov_b32 v10, 0xffff
    v_mov_b32 v11, 0
    v_lshlrev_b64 v[10:11], v25, v[10:11]
    v_cmp_gt_u32 vcc, 4, v4
    s_nop 1
    v_cndmask_b32 v8, 0, v10, vcc
    v_cndmask_b32 v9, 0, v11, vcc
    v_cndmask_b32 v10, v10, 0, vcc
    v_cndmask_b32 v11, v11, 0, vcc
    s_mov_b32 s12, 4608
    v_mul_lo_u32 v28, v7, s12
    v_lshl_add_u32 v29, v28, 3, v6
    v_add_u32 v28, v28, v6
    s_mul_i32 s12, s4, 294912
    s_mul_i32 s13, s3, 36864
    s_add_u32 s12, s12, s13
    s_min_u32 s38, s5, 8
    s_lshl_b32 s38, s38, 7
    s_add_u32 s14, s12, s38
    s_add_u32 s46, s24, s14
    s_addc_u32 s47, s25, 0
    s_mov_b32 s48, s28
    s_mov_b32 s49, s29
    s_mov_b32 s50, 5308416
    s_mov_b32 s51, 0x20000
    s_max_u32 s59, s2, 184
    s_sub_u32 s59, s59, 184
    s_mul_i32 s13, s3, 589824
    s_lshl_b32 s12, s59, 7
    s_add_u32 s56, s12, s13
    s_mul_i32 s12, s59, 73728
    s_lshl_b32 s13, s3, 7
    s_add_u32 s12, s12, s13
    s_add_u32 s52, s30, s12
    s_addc_u32 s53, s31, 0
    s_add_u32 s54, s52, 36864
    s_addc_u32 s55, s53, 0
    v_lshlrev_b32 v22, 5, v0
    v_lshlrev_b32 v23, 2, v0
    s_mul_i32 s12, s8, 576
    v_lshlrev_b32 v24, 6, v3
    v_add_u32 v24, s12, v24
    v_lshlrev_b32 v25, 3, v3
    v_add_u32 v25, s12, v25

    s_mov_b32 s12, 0x3ae38e39
    s_mov_b32 s13, 0x3727c5ac
    s_waitcnt vmcnt(18)
    v_lshlrev_b32 v104, 16, v16
    v_and_b32 v105, 0xffff0000, v16
    v_lshlrev_b32 v106, 16, v17
    v_and_b32 v107, 0xffff0000, v17
    v_lshlrev_b32 v108, 16, v18
    v_and_b32 v109, 0xffff0000, v18
    v_lshlrev_b32 v110, 16, v19
    v_and_b32 v111, 0xffff0000, v19
    v_lshlrev_b32 v112, 16, v20
    v_add_f32 v16, v104, v105
    v_add_f32 v17, v106, v107
    v_add_f32 v18, v108, v109
    v_add_f32 v19, v110, v111
    v_add_f32 v16, v16, v17
    v_add_f32 v18, v18, v19
    v_add_f32 v16, v16, v112
    v_add_f32 v16, v16, v18
    s_nop 1
    v_add_f32_dpp v16, v16, v16 row_ror:8 row_mask:0xf bank_mask:0xf
    s_nop 1
    v_add_f32_dpp v16, v16, v16 row_ror:4 row_mask:0xf bank_mask:0xf
    s_nop 1
    v_add_f32_dpp v16, v16, v16 row_ror:2 row_mask:0xf bank_mask:0xf
    s_nop 1
    v_add_f32_dpp v16, v16, v16 row_ror:1 row_mask:0xf bank_mask:0xf
    v_mov_b32 v17, v16
    s_nop 1
    v_permlane16_swap_b32 v16, v17
    v_add_f32 v16, v16, v17
    v_mov_b32 v17, v16
    s_nop 1
    v_permlane32_swap_b32 v16, v17
    v_add_f32 v16, v16, v17
    v_mul_f32 v16, s12, v16
    v_sub_f32 v113, v104, v16
    v_sub_f32 v114, v105, v16
    v_sub_f32 v115, v106, v16
    v_sub_f32 v116, v107, v16
    v_sub_f32 v117, v108, v16
    v_sub_f32 v118, v109, v16
    v_sub_f32 v119, v110, v16
    v_sub_f32 v120, v111, v16
    v_sub_f32 v121, v112, v16
    v_mul_f32 v17, v113, v113
    v_mul_f32 v18, v114, v114
    v_fma_f32 v17, v115, v115, v17
    v_fma_f32 v18, v116, v116, v18
    v_fma_f32 v17, v117, v117, v17
    v_fma_f32 v18, v118, v118, v18
    v_fma_f32 v17, v119, v119, v17
    v_fma_f32 v18, v120, v120, v18
    v_fma_f32 v17, v121, v121, v17
    v_add_f32 v17, v17, v18
    s_nop 1
    v_add_f32_dpp v17, v17, v17 row_ror:8 row_mask:0xf bank_mask:0xf
    s_nop 1
    v_add_f32_dpp v17, v17, v17 row_ror:4 row_mask:0xf bank_mask:0xf
    s_nop 1
    v_add_f32_dpp v17, v17, v17 row_ror:2 row_mask:0xf bank_mask:0xf
    s_nop 1
    v_add_f32_dpp v17, v17, v17 row_ror:1 row_mask:0xf bank_mask:0xf
    v_mov_b32 v18, v17
    s_nop 1
    v_permlane16_swap_b32 v17, v18
    v_add_f32 v17, v17, v18
    v_mov_b32 v18, v17
    s_nop 1
    v_permlane32_swap_b32 v17, v18
    v_add_f32 v17, v17, v18
    v_mul_f32 v17, s12, v17
    v_cvt_pk_bf16_f32 v17, v17, v17
    v_and_b32 v17, 0xffff0000, v17
    v_cvt_pk_bf16_f32 v16, v16, v16
    v_and_b32 v16, 0xffff0000, v16
    v_add_f32 v17, s13, v17
    v_cvt_pk_bf16_f32 v17, v17, v17
    v_and_b32 v17, 0xffff0000, v17
    v_sqrt_f32 v17, v17
    v_sub_f32 v104, v104, v16
    v_sub_f32 v105, v105, v16
    v_sub_f32 v106, v106, v16
    v_sub_f32 v107, v107, v16
    v_sub_f32 v108, v108, v16
    v_sub_f32 v109, v109, v16
    v_sub_f32 v110, v110, v16
    v_sub_f32 v111, v111, v16
    v_sub_f32 v112, v112, v16
    v_cvt_pk_bf16_f32 v17, v17, v17
    v_and_b32 v17, 0xffff0000, v17
    v_rcp_f32 v17, v17
    v_cvt_pk_bf16_f32 v104, v104, v104
    v_and_b32 v104, 0xffff0000, v104
    v_cvt_pk_bf16_f32 v105, v105, v105
    v_and_b32 v105, 0xffff0000, v105
    v_cvt_pk_bf16_f32 v106, v106, v106
    v_and_b32 v106, 0xffff0000, v106
    v_cvt_pk_bf16_f32 v107, v107, v107
    v_and_b32 v107, 0xffff0000, v107
    v_cvt_pk_bf16_f32 v108, v108, v108
    v_and_b32 v108, 0xffff0000, v108
    v_cvt_pk_bf16_f32 v109, v109, v109
    v_and_b32 v109, 0xffff0000, v109
    v_cvt_pk_bf16_f32 v110, v110, v110
    v_and_b32 v110, 0xffff0000, v110
    v_cvt_pk_bf16_f32 v111, v111, v111
    v_and_b32 v111, 0xffff0000, v111
    v_cvt_pk_bf16_f32 v112, v112, v112
    v_and_b32 v112, 0xffff0000, v112
    v_mul_f32 v104, v104, v17
    v_mul_f32 v105, v105, v17
    v_mul_f32 v106, v106, v17
    v_mul_f32 v107, v107, v17
    v_mul_f32 v108, v108, v17
    v_mul_f32 v109, v109, v17
    v_mul_f32 v110, v110, v17
    v_mul_f32 v111, v111, v17
    v_mul_f32 v112, v112, v17
    v_cvt_pk_bf16_f32 v104, v104, v104
    v_cvt_pk_bf16_f32 v105, v105, v105
    v_cvt_pk_bf16_f32 v106, v106, v106
    v_cvt_pk_bf16_f32 v107, v107, v107
    v_cvt_pk_bf16_f32 v108, v108, v108
    v_cvt_pk_bf16_f32 v109, v109, v109
    v_cvt_pk_bf16_f32 v110, v110, v110
    v_cvt_pk_bf16_f32 v111, v111, v111
    v_cvt_pk_bf16_f32 v112, v112, v112
    ds_write_b128 v22, v[104:107] offset:0
    ds_write_b128 v22, v[108:111] offset:16
    ds_write_b32 v23, v112 offset:2048
    s_waitcnt lgkmcnt(0)
    ds_read_b128 v[104:107], v24 offset:0
    ds_read_b128 v[108:111], v24 offset:16
    ds_read_b128 v[112:115], v24 offset:32
    ds_read_b128 v[116:119], v24 offset:48
    ds_read_b64 v[120:121], v25 offset:512
    s_lshl_b32 s12, s4, 14
    s_lshl_b32 s13, s5, 10
    s_add_u32 s12, s12, s13
    s_add_u32 s12, s12, 262144
    s_lshl_b32 s13, s4, 12
    s_lshl_b32 s14, s5, 8
    s_add_u32 s13, s13, s14
    s_add_u32 s13, s13, 65536
    v_add_u32 v26, s12, v21
    v_add_u32 v27, s13, v21
    v_mov_b32 v124, s6
    v_mov_b32 v125, s6
    v_mov_b32 v126, s6
    v_mov_b32 v127, s6
    s_mov_b64 exec, 0xffff
    global_store_dwordx4 v27, v[124:127], s[36:37]
    s_mov_b64 exec, -1
    global_store_dwordx4 v26, v[124:127], s[36:37]
    s_add_u32 s6, s6, 1
    v_mov_b32 v5, s6
    s_lshl_b32 s12, s4, 12
    s_add_u32 s12, s12, 65536
    v_add_u32 v21, s12, v21
    s_lshl_b32 s13, s8, 10
    s_add_u32 s12, s12, s13
    s_lshl_b32 s13, s9, 8
    s_add_u32 s12, s12, s13
    v_lshlrev_b32 v22, 4, v2
    v_lshl_or_b32 v22, v1, 6, v22
    v_add_u32 v22, s12, v22
    v_xor_b32 v23, 196608, v22
    s_waitcnt lgkmcnt(0)
    v_and_b32 v16, v104, v8
    v_and_b32 v17, v104, v9
    v_and_b32 v18, v104, v10
    v_and_b32 v19, v104, v11
    s_waitcnt vmcnt(19)
    s_nop 0
    v_mfma_f32_16x16x32_bf16 v[24:27], v[16:19], v[32:35], 0
    v_and_b32 v124, v105, v8
    v_and_b32 v125, v105, v9
    v_and_b32 v126, v105, v10
    v_and_b32 v127, v105, v11
    s_waitcnt vmcnt(18)
    s_nop 0
    v_mfma_f32_16x16x32_bf16 v[24:27], v[124:127], v[36:39], v[24:27]
    v_and_b32 v16, v106, v8
    v_and_b32 v17, v106, v9
    v_and_b32 v18, v106, v10
    v_and_b32 v19, v106, v11
    s_waitcnt vmcnt(17)
    s_nop 0
    v_mfma_f32_16x16x32_bf16 v[24:27], v[16:19], v[40:43], v[24:27]
    v_and_b32 v124, v107, v8
    v_and_b32 v125, v107, v9
    v_and_b32 v126, v107, v10
    v_and_b32 v127, v107, v11
    s_waitcnt vmcnt(16)
    s_nop 0
    v_mfma_f32_16x16x32_bf16 v[24:27], v[124:127], v[44:47], v[24:27]
    v_and_b32 v16, v108, v8
    v_and_b32 v17, v108, v9
    v_and_b32 v18, v108, v10
    v_and_b32 v19, v108, v11
    s_waitcnt vmcnt(15)
    s_nop 0
    v_mfma_f32_16x16x32_bf16 v[24:27], v[16:19], v[48:51], v[24:27]
    v_and_b32 v124, v109, v8
    v_and_b32 v125, v109, v9
    v_and_b32 v126, v109, v10
    v_and_b32 v127, v109, v11
    s_waitcnt vmcnt(14)
    s_nop 0
    v_mfma_f32_16x16x32_bf16 v[24:27], v[124:127], v[52:55], v[24:27]
    v_and_b32 v16, v110, v8
    v_and_b32 v17, v110, v9
    v_and_b32 v18, v110, v10
    v_and_b32 v19, v110, v11
    s_waitcnt vmcnt(13)
    s_nop 0
    v_mfma_f32_16x16x32_bf16 v[24:27], v[16:19], v[56:59], v[24:27]
    v_and_b32 v124, v111, v8
    v_and_b32 v125, v111, v9
    v_and_b32 v126, v111, v10
    v_and_b32 v127, v111, v11
    s_waitcnt vmcnt(12)
    s_nop 0
    v_mfma_f32_16x16x32_bf16 v[24:27], v[124:127], v[60:63], v[24:27]
    v_and_b32 v16, v112, v8
    v_and_b32 v17, v112, v9
    v_and_b32 v18, v112, v10
    v_and_b32 v19, v112, v11
    s_waitcnt vmcnt(11)
    s_nop 0
    v_mfma_f32_16x16x32_bf16 v[24:27], v[16:19], v[64:67], v[24:27]
    v_and_b32 v124, v113, v8
    v_and_b32 v125, v113, v9
    v_and_b32 v126, v113, v10
    v_and_b32 v127, v113, v11
    s_waitcnt vmcnt(10)
    s_nop 0
    v_mfma_f32_16x16x32_bf16 v[24:27], v[124:127], v[68:71], v[24:27]
    v_and_b32 v16, v114, v8
    v_and_b32 v17, v114, v9
    v_and_b32 v18, v114, v10
    v_and_b32 v19, v114, v11
    s_waitcnt vmcnt(9)
    s_nop 0
    v_mfma_f32_16x16x32_bf16 v[24:27], v[16:19], v[72:75], v[24:27]
    v_and_b32 v124, v115, v8
    v_and_b32 v125, v115, v9
    v_and_b32 v126, v115, v10
    v_and_b32 v127, v115, v11
    s_waitcnt vmcnt(8)
    s_nop 0
    v_mfma_f32_16x16x32_bf16 v[24:27], v[124:127], v[76:79], v[24:27]
    v_and_b32 v16, v116, v8
    v_and_b32 v17, v116, v9
    v_and_b32 v18, v116, v10
    v_and_b32 v19, v116, v11
    s_waitcnt vmcnt(7)
    s_nop 0
    v_mfma_f32_16x16x32_bf16 v[24:27], v[16:19], v[80:83], v[24:27]
    v_and_b32 v124, v117, v8
    v_and_b32 v125, v117, v9
    v_and_b32 v126, v117, v10
    v_and_b32 v127, v117, v11
    s_waitcnt vmcnt(6)
    s_nop 0
    v_mfma_f32_16x16x32_bf16 v[24:27], v[124:127], v[84:87], v[24:27]
    v_and_b32 v16, v118, v8
    v_and_b32 v17, v118, v9
    v_and_b32 v18, v118, v10
    v_and_b32 v19, v118, v11
    s_waitcnt vmcnt(5)
    s_nop 0
    v_mfma_f32_16x16x32_bf16 v[24:27], v[16:19], v[88:91], v[24:27]
    v_and_b32 v124, v119, v8
    v_and_b32 v125, v119, v9
    v_and_b32 v126, v119, v10
    v_and_b32 v127, v119, v11
    s_waitcnt vmcnt(4)
    s_nop 0
    v_mfma_f32_16x16x32_bf16 v[24:27], v[124:127], v[92:95], v[24:27]
    v_and_b32 v16, v120, v8
    v_and_b32 v17, v120, v9
    v_and_b32 v18, v120, v10
    v_and_b32 v19, v120, v11
    s_waitcnt vmcnt(3)
    s_nop 0
    v_mfma_f32_16x16x32_bf16 v[24:27], v[16:19], v[96:99], v[24:27]
    v_and_b32 v124, v121, v8
    v_and_b32 v125, v121, v9
    v_and_b32 v126, v121, v10
    v_and_b32 v127, v121, v11
    s_waitcnt vmcnt(2)
    s_nop 0
    v_mfma_f32_16x16x32_bf16 v[24:27], v[124:127], v[100:103], v[24:27]
    s_nop 7
    v_add_f32_dpp v16, v25, v24 row_ror:8 row_mask:0xf bank_mask:0xf
    v_add_f32_dpp v17, v27, v26 row_ror:8 row_mask:0xf bank_mask:0xf
    v_add_f32_dpp v18, v25, v24 row_ror:8 row_mask:0xf bank_mask:0xf
    v_add_f32_dpp v19, v27, v26 row_ror:8 row_mask:0xf bank_mask:0xf
    s_nop 0
    v_permlane16_swap_b32 v16, v18
    v_permlane16_swap_b32 v17, v19
    v_bfi_b32 v16, s7, v5, v16
    v_bfi_b32 v17, s7, v5, v17
    v_bfi_b32 v18, s7, v5, v18
    v_bfi_b32 v19, s7, v5, v19
    s_mov_b32 exec_lo, 0xff
    s_mov_b32 exec_hi, 0xff
    global_store_dwordx4 v22, v[16:19], s[36:37]
    global_store_dwordx4 v23, v[16:19], s[36:37] sc1
    s_mov_b64 exec, -1
    v_lshlrev_b32 v23, 7, v1
    v_or_b32 v23, v23, v6
    v_and_b32 v22, 8, v0
    v_or_b32 v23, v23, v22
    s_mov_b32 s60, 0
    v_mov_b32 v22, v21
    s_sleep 4
    s_mov_b64 s[64:65], -1
    s_mov_b64 s[66:67], -1
    s_mov_b64 s[68:69], -1
    s_mov_b64 s[70:71], -1
    global_load_dwordx4 v[32:35], v21, s[36:37] offset:0 sc1
    global_load_dwordx4 v[36:39], v21, s[36:37] offset:1024 sc1
    global_load_dwordx4 v[40:43], v21, s[36:37] offset:2048 sc1
    global_load_dwordx4 v[44:47], v21, s[36:37] offset:3072 sc1
    s_sleep 8
    global_load_dwordx4 v[32:35], v21, s[36:37] offset:0 sc1
    global_load_dwordx4 v[36:39], v21, s[36:37] offset:1024 sc1
    global_load_dwordx4 v[40:43], v21, s[36:37] offset:2048 sc1
    global_load_dwordx4 v[44:47], v21, s[36:37] offset:3072 sc1
    s_sleep 8
L_pq:
    s_mov_b64 exec, s[64:65]
    global_load_dwordx4 v[32:35], v21, s[36:37] offset:0 sc1
    s_mov_b64 exec, s[66:67]
    global_load_dwordx4 v[36:39], v21, s[36:37] offset:1024 sc1
    s_mov_b64 exec, s[68:69]
    global_load_dwordx4 v[40:43], v21, s[36:37] offset:2048 sc1
    s_mov_b64 exec, s[70:71]
    global_load_dwordx4 v[44:47], v21, s[36:37] offset:3072 sc1
    s_mov_b64 exec, -1
    s_add_u32 s60, s60, 1
    s_cmp_gt_u32 s60, 24
    s_cbranch_scc1 L_pq_f
    s_waitcnt vmcnt(11)
    v_xor_b32 v20, v32, v5
    v_bitop3_b32 v20, v20, v33, v5 bitop3:0xf6
    v_bitop3_b32 v20, v20, v34, v5 bitop3:0xf6
    v_bitop3_b32 v20, v20, v35, v5 bitop3:0xf6
    v_and_b32 v20, s7, v20
    v_cmp_ne_u32_e64 s[64:65], 0, v20
    s_waitcnt vmcnt(10)
    v_xor_b32 v20, v36, v5
    v_bitop3_b32 v20, v20, v37, v5 bitop3:0xf6
    v_bitop3_b32 v20, v20, v38, v5 bitop3:0xf6
    v_bitop3_b32 v20, v20, v39, v5 bitop3:0xf6
    v_and_b32 v20, s7, v20
    v_cmp_ne_u32_e64 s[66:67], 0, v20
    s_waitcnt vmcnt(9)
    v_xor_b32 v20, v40, v5
    v_bitop3_b32 v20, v20, v41, v5 bitop3:0xf6
    v_bitop3_b32 v20, v20, v42, v5 bitop3:0xf6
    v_bitop3_b32 v20, v20, v43, v5 bitop3:0xf6
    v_and_b32 v20, s7, v20
    v_cmp_ne_u32_e64 s[68:69], 0, v20
    s_waitcnt vmcnt(8)
    v_xor_b32 v20, v44, v5
    v_bitop3_b32 v20, v20, v45, v5 bitop3:0xf6
    v_bitop3_b32 v20, v20, v46, v5 bitop3:0xf6
    v_bitop3_b32 v20, v20, v47, v5 bitop3:0xf6
    v_and_b32 v20, s7, v20
    v_cmp_ne_u32_e64 s[70:71], 0, v20
    s_or_b64 s[72:73], s[64:65], s[66:67]
    s_or_b64 s[72:73], s[72:73], s[68:69]
    s_or_b64 s[72:73], s[72:73], s[70:71]
    s_cbranch_scc0 L_pq_x
    s_branch L_pq
L_pq_f:
    s_waitcnt vmcnt(3)
    v_xor_b32 v20, v32, v5
    v_bitop3_b32 v20, v20, v33, v5 bitop3:0xf6
    v_bitop3_b32 v20, v20, v34, v5 bitop3:0xf6
    v_bitop3_b32 v20, v20, v35, v5 bitop3:0xf6
    v_and_b32 v20, s7, v20
    v_cmp_ne_u32_e64 s[64:65], 0, v20
    s_waitcnt vmcnt(2)
    v_xor_b32 v20, v36, v5
    v_bitop3_b32 v20, v20, v37, v5 bitop3:0xf6
    v_bitop3_b32 v20, v20, v38, v5 bitop3:0xf6
    v_bitop3_b32 v20, v20, v39, v5 bitop3:0xf6
    v_and_b32 v20, s7, v20
    v_cmp_ne_u32_e64 s[66:67], 0, v20
    s_waitcnt vmcnt(1)
    v_xor_b32 v20, v40, v5
    v_bitop3_b32 v20, v20, v41, v5 bitop3:0xf6
    v_bitop3_b32 v20, v20, v42, v5 bitop3:0xf6
    v_bitop3_b32 v20, v20, v43, v5 bitop3:0xf6
    v_and_b32 v20, s7, v20
    v_cmp_ne_u32_e64 s[68:69], 0, v20
    s_waitcnt vmcnt(0)
    v_xor_b32 v20, v44, v5
    v_bitop3_b32 v20, v20, v45, v5 bitop3:0xf6
    v_bitop3_b32 v20, v20, v46, v5 bitop3:0xf6
    v_bitop3_b32 v20, v20, v47, v5 bitop3:0xf6
    v_and_b32 v20, s7, v20
    v_cmp_ne_u32_e64 s[70:71], 0, v20
    s_or_b64 s[72:73], s[64:65], s[66:67]
    s_or_b64 s[72:73], s[72:73], s[68:69]
    s_or_b64 s[72:73], s[72:73], s[70:71]
    s_cbranch_scc0 L_pq_x
    s_bitcmp1_b32 s60, 0
    s_cselect_b32 s61, 196608, 0
    v_xor_b32 v21, s61, v22
    s_mov_b64 exec, s[64:65]
    global_load_dwordx4 v[32:35], v21, s[36:37] offset:0 sc1
    s_mov_b64 exec, s[66:67]
    global_load_dwordx4 v[36:39], v21, s[36:37] offset:1024 sc1
    s_mov_b64 exec, s[68:69]
    global_load_dwordx4 v[40:43], v21, s[36:37] offset:2048 sc1
    s_mov_b64 exec, s[70:71]
    global_load_dwordx4 v[44:47], v21, s[36:37] offset:3072 sc1
    s_mov_b64 exec, -1
    s_add_u32 s60, s60, 1
    s_cmp_gt_u32 s60, 100000
    s_cbranch_scc0 L_pq_f
L_pq_x:
    v_add_f32 v104, v32, v36
    v_add_f32 v108, v40, v44
    v_add_f32 v105, v33, v37
    v_add_f32 v109, v41, v45
    v_add_f32 v106, v34, v38
    v_add_f32 v110, v42, v46
    v_add_f32 v107, v35, v39
    v_add_f32 v111, v43, v47
    v_add_f32 v104, v104, v108
    v_add_f32 v105, v105, v109
    v_add_f32 v106, v106, v110
    v_add_f32 v107, v107, v111
    v_cvt_pk_bf16_f32 v104, v104, v105
    v_cvt_pk_bf16_f32 v105, v106, v107
    ds_write_b64 v23, v[104:105] offset:2560
    s_waitcnt lgkmcnt(0)
    s_barrier
    v_lshrrev_b32 v16, 1, v1
    v_lshlrev_b32 v17, 7, v16
    v_lshlrev_b32 v18, 9, v16
    v_lshl_or_b32 v18, v2, 5, v18
    v_and_b32 v19, 1, v1
    v_lshl_or_b32 v18, v19, 4, v18
    s_lshl_b32 s12, s4, 14
    s_lshl_b32 s13, s5, 10
    s_add_u32 s12, s12, s13
    s_add_u32 s12, s12, 262144
    v_add_u32 v18, s12, v18
    v_xor_b32 v16, 786432, v18
    v_lshlrev_b32 v19, 4, v0
    s_barrier
    ds_read_b128 v[128:131], v17 offset:3072
    ds_read_b128 v[132:135], v17 offset:3088
    ds_read_b128 v[136:139], v17 offset:3104
    ds_read_b128 v[140:143], v17 offset:3120
    ds_read_b128 v[144:147], v17 offset:3136
    ds_read_b128 v[148:151], v17 offset:3152
    s_waitcnt lgkmcnt(0)
    v_max3_f32 v20, v128, v130, v132
    v_max3_f32 v21, v134, v136, v138
    v_max3_f32 v22, v140, v142, v144
    v_max3_f32 v20, v146, v148, v20
    v_max3_f32 v20, v20, v21, v22
    v_sub_f32 v128, v128, v20
    v_sub_f32 v130, v130, v20
    v_sub_f32 v132, v132, v20
    v_sub_f32 v134, v134, v20
    v_sub_f32 v136, v136, v20
    v_sub_f32 v138, v138, v20
    v_sub_f32 v140, v140, v20
    v_sub_f32 v142, v142, v20
    v_sub_f32 v144, v144, v20
    v_sub_f32 v146, v146, v20
    v_sub_f32 v148, v148, v20
    v_exp_f32 v128, v128
    v_exp_f32 v130, v130
    v_exp_f32 v132, v132
    v_exp_f32 v134, v134
    v_exp_f32 v136, v136
    v_exp_f32 v138, v138
    v_exp_f32 v140, v140
    v_exp_f32 v142, v142
    v_exp_f32 v144, v144
    v_exp_f32 v146, v146
    v_exp_f32 v148, v148
    v_mul_f32 v21, v128, v129
    v_mul_f32 v22, v130, v131
    v_fma_f32 v21, v132, v133, v21
    v_fma_f32 v22, v134, v135, v22
    v_fma_f32 v21, v136, v137, v21
    v_fma_f32 v22, v138, v139, v22
    v_fma_f32 v21, v140, v141, v21
    v_fma_f32 v22, v142, v143, v22
    v_fma_f32 v21, v144, v145, v21
    v_fma_f32 v22, v146, v147, v22
    v_fma_f32 v21, v148, v149, v21
    v_add_f32 v21, v21, v22
    v_rcp_f32 v22, v21
    v_log_f32 v21, v21
    v_mul_f32 v128, v128, v22
    v_mul_f32 v130, v130, v22
    v_mul_f32 v132, v132, v22
    v_mul_f32 v134, v134, v22
    v_mul_f32 v136, v136, v22
    v_mul_f32 v138, v138, v22
    v_mul_f32 v140, v140, v22
    v_mul_f32 v142, v142, v22
    v_mul_f32 v144, v144, v22
    v_mul_f32 v146, v146, v22
    v_mul_f32 v148, v148, v22
    v_add_f32 v26, v20, v21
    v_mov_b32 v27, v5
    s_barrier
    ds_read_b128 v[48:51], v19 offset:12288
    ds_read_b128 v[52:55], v19 offset:13312
    ds_read_b128 v[56:59], v19 offset:14336
    ds_read_b128 v[60:63], v19 offset:15360
    ds_read_b128 v[64:67], v19 offset:16384
    ds_read_b128 v[68:71], v19 offset:17408
    ds_read_b128 v[72:75], v19 offset:18432
    ds_read_b128 v[76:79], v19 offset:19456
    ds_read_b128 v[80:83], v19 offset:20480
    ds_read_b128 v[84:87], v19 offset:21504
    ds_read_b128 v[88:91], v19 offset:22528
    s_waitcnt lgkmcnt(10)
    v_pk_mul_f32 v[20:21], v[48:49], v[128:129] op_sel_hi:[1,0]
    v_pk_mul_f32 v[22:23], v[50:51], v[128:129] op_sel_hi:[1,0]
    s_waitcnt lgkmcnt(9)
    v_pk_fma_f32 v[20:21], v[52:53], v[130:131], v[20:21] op_sel_hi:[1,0,1]
    v_pk_fma_f32 v[22:23], v[54:55], v[130:131], v[22:23] op_sel_hi:[1,0,1]
    s_waitcnt lgkmcnt(8)
    v_pk_fma_f32 v[20:21], v[56:57], v[132:133], v[20:21] op_sel_hi:[1,0,1]
    v_pk_fma_f32 v[22:23], v[58:59], v[132:133], v[22:23] op_sel_hi:[1,0,1]
    s_waitcnt lgkmcnt(7)
    v_pk_fma_f32 v[20:21], v[60:61], v[134:135], v[20:21] op_sel_hi:[1,0,1]
    v_pk_fma_f32 v[22:23], v[62:63], v[134:135], v[22:23] op_sel_hi:[1,0,1]
    s_waitcnt lgkmcnt(6)
    v_pk_fma_f32 v[20:21], v[64:65], v[136:137], v[20:21] op_sel_hi:[1,0,1]
    v_pk_fma_f32 v[22:23], v[66:67], v[136:137], v[22:23] op_sel_hi:[1,0,1]
    s_waitcnt lgkmcnt(5)
    v_pk_fma_f32 v[20:21], v[68:69], v[138:139], v[20:21] op_sel_hi:[1,0,1]
    v_pk_fma_f32 v[22:23], v[70:71], v[138:139], v[22:23] op_sel_hi:[1,0,1]
    s_waitcnt lgkmcnt(4)
    v_pk_fma_f32 v[20:21], v[72:73], v[140:141], v[20:21] op_sel_hi:[1,0,1]
    v_pk_fma_f32 v[22:23], v[74:75], v[140:141], v[22:23] op_sel_hi:[1,0,1]
    s_waitcnt lgkmcnt(3)
    v_pk_fma_f32 v[20:21], v[76:77], v[142:143], v[20:21] op_sel_hi:[1,0,1]
    v_pk_fma_f32 v[22:23], v[78:79], v[142:143], v[22:23] op_sel_hi:[1,0,1]
    s_waitcnt lgkmcnt(2)
    v_pk_fma_f32 v[20:21], v[80:81], v[144:145], v[20:21] op_sel_hi:[1,0,1]
    v_pk_fma_f32 v[22:23], v[82:83], v[144:145], v[22:23] op_sel_hi:[1,0,1]
    s_waitcnt lgkmcnt(1)
    v_pk_fma_f32 v[20:21], v[84:85], v[146:147], v[20:21] op_sel_hi:[1,0,1]
    v_pk_fma_f32 v[22:23], v[86:87], v[146:147], v[22:23] op_sel_hi:[1,0,1]
    s_waitcnt lgkmcnt(0)
    v_pk_fma_f32 v[20:21], v[88:89], v[148:149], v[20:21] op_sel_hi:[1,0,1]
    v_pk_fma_f32 v[22:23], v[90:91], v[148:149], v[22:23] op_sel_hi:[1,0,1]
    v_cvt_pk_bf16_f32 v24, v20, v21
    v_cvt_pk_bf16_f32 v25, v22, v23
    global_store_dwordx4 v18, v[24:27], s[36:37]
    global_store_dwordx4 v16, v[24:27], s[36:37] sc1
    s_cmp_ge_u32 s2, 184
    s_cbranch_scc1 L_fq
    s_cmp_ge_u32 s2, 144
    s_cbranch_scc1 L_fin
    s_lshl_b32 s13, s4, 8
    s_add_u32 s13, s13, 786432
    s_lshl_b32 s12, s38, 5
    s_add_u32 s12, s12, s13
    v_add_u32 v18, s12, v19
    s_mov_b64 exec, 0xffff
    s_waitcnt vmcnt(0)
    s_barrier
    ds_read_b128 v[32:35], v19 offset:3328
    ds_read_b128 v[36:39], v19 offset:3584
    ds_read_b128 v[40:43], v19 offset:3840
    ds_read_b128 v[44:47], v19 offset:4096
    ds_read_b128 v[48:51], v19 offset:4352
    ds_read_b128 v[52:55], v19 offset:4608
    ds_read_b128 v[56:59], v19 offset:4864
    ds_read_b128 v[60:63], v19 offset:5120
    s_waitcnt lgkmcnt(6)
    v_pk_add_f32 v[32:33], v[32:33], v[36:37]
    v_pk_add_f32 v[34:35], v[34:35], v[38:39]
    s_waitcnt lgkmcnt(4)
    v_pk_add_f32 v[40:41], v[40:41], v[44:45]
    v_pk_add_f32 v[42:43], v[42:43], v[46:47]
    s_waitcnt lgkmcnt(2)
    v_pk_add_f32 v[48:49], v[48:49], v[52:53]
    v_pk_add_f32 v[50:51], v[50:51], v[54:55]
    v_pk_add_f32 v[32:33], v[32:33], v[40:41]
    v_pk_add_f32 v[34:35], v[34:35], v[42:43]
    s_waitcnt lgkmcnt(0)
    v_pk_add_f32 v[56:57], v[56:57], v[60:61]
    v_pk_add_f32 v[58:59], v[58:59], v[62:63]
    v_pk_add_f32 v[32:33], v[32:33], v[48:49]
    v_pk_add_f32 v[34:35], v[34:35], v[50:51]
    v_pk_add_f32 v[32:33], v[32:33], v[56:57]
    v_pk_add_f32 v[34:35], v[34:35], v[58:59]
    v_bfi_b32 v32, s7, v5, v32
    v_bfi_b32 v33, s7, v5, v33
    v_bfi_b32 v34, s7, v5, v34
    v_bfi_b32 v35, s7, v5, v35
    global_store_dwordx4 v18, v[32:35], s[36:37] sc1
    s_mov_b64 exec, -1
    s_branch L_fin
L_fq:
L_fin:
L_end:
    s_endpgm

.section .rodata,"a"
.p2align 6
.amdhsa_kernel sequential_preLN__sliding_block_cached__dense_activation_silu__decode_kernel
  .amdhsa_next_free_vgpr 160
  .amdhsa_next_free_sgpr 102
  .amdhsa_accum_offset 160
  .amdhsa_group_segment_fixed_size 0
  .amdhsa_kernarg_size 88
  .amdhsa_user_sgpr_count 2
  .amdhsa_user_sgpr_kernarg_segment_ptr 1
  .amdhsa_system_sgpr_workgroup_id_x 1
.end_amdhsa_kernel
```
